```python
import torch

def _softmax(x, axis=-1):
    return torch.softmax(x, dim=axis)
def _gelu(x):
    return torch.nn.functional.gelu(x, approximate="tanh")
def _silu(x):
    return torch.nn.functional.silu(x)
def _sigmoid(x):
    return torch.sigmoid(x)
def _layernorm(x, axis=-1, eps=1e-5):
    m = x.mean(dim=axis, keepdim=True)
    v = x.var(dim=axis, keepdim=True, unbiased=False)
    return (x - m) / torch.sqrt(v + eps)
def _scatter_add(tgt, idx, src, axis=0):
    return tgt.clone().index_add_(axis, idx, src)
def _segment_sum(src, seg, n):
    out = torch.zeros((n,) + src.shape[1:], dtype=src.dtype)
    return out.index_add_(0, seg, src)
def _pad(x, pw):
    flat = tuple(v for pair in reversed(pw) for v in pair)
    return torch.nn.functional.pad(x, flat)

kernel_name = 'concat_heads__compressed_kv_cla__sliding_block_cached__decode'

def setup_inputs():

    _w = (lambda a: (lambda t: t.to(torch.bfloat16) if t.is_floating_point() else t)(torch.as_tensor(a)))
    def _A_setup():
        B, H, Sq, Sk, D, M = 4, 32, 1, 4096, 128, 512
        Dc = 4 * D
        return {
            "x": _w((lambda *s: torch.randn(*s, dtype=torch.bfloat16) * 3.2)(B, Sq, M)),
            "c_kv": _w((lambda *s: torch.randn(*s, dtype=torch.bfloat16) * 0.1)(B, Sk, Dc)),
            "w_q": _w((lambda *s: torch.randn(*s, dtype=torch.bfloat16) * 6.4)(M, H, D) * (M ** -0.5)),
            "w_uk": _w((lambda *s: torch.randn(*s, dtype=torch.bfloat16) * 6.4)(Dc, H, D) * (Dc ** -0.5)),
            "w_uv": _w((lambda *s: torch.randn(*s, dtype=torch.bfloat16) * 0.1)(Dc, H, D) * (Dc ** -0.5)),
            "w_o": _w((lambda *s: torch.randn(*s, dtype=torch.bfloat16) * 0.1)(H, D, M) * ((H * D) ** -0.5)),
        }
    _A_in = _A_setup()

    def _B_setup():
        B, Sq, D = 4, 1, 512
        Hq, Hkv, Sk, Dh = 32, 8, 4096, 128
        assert Hq % Hkv == 0, (Hq, Hkv)
        return {
            "x": _w((lambda *s: torch.randn(*s, dtype=torch.bfloat16) * 1.6)(B, Sq, D)),
            "k_cache": _w((lambda *s: torch.randn(*s, dtype=torch.bfloat16) * 1.6)(B, Hkv, Sk, Dh)),
            "v_cache": _w((lambda *s: torch.randn(*s, dtype=torch.bfloat16) * 0.05)(B, Hkv, Sk, Dh)),
            "wq": _w((lambda *s: torch.randn(*s, dtype=torch.bfloat16) * 1.6)(D, Hq * Dh) * (D ** -0.5)),
            "wo": _w((lambda *s: torch.randn(*s, dtype=torch.bfloat16) * 0.05)(Hq * Dh, D) * ((Hq * Dh) ** -0.5)),
        }
    _B_in = _B_setup()

    return {
        "A_x": _A_in["x"],
        "A_c_kv": _A_in["c_kv"],
        "A_w_q": _A_in["w_q"],
        "A_w_uk": _A_in["w_uk"],
        "A_w_uv": _A_in["w_uv"],
        "A_w_o": _A_in["w_o"],
        "B_x": _B_in["x"],
        "B_k_cache": _B_in["k_cache"],
        "B_v_cache": _B_in["v_cache"],
        "B_wq": _B_in["wq"],
        "B_wo": _B_in["wo"],
    }

def reference(A_x, A_c_kv, A_w_q, A_w_uk, A_w_uv, A_w_o, B_x, B_k_cache, B_v_cache, B_wq, B_wo):
    def _A_ref(x, c_kv, w_q, w_uk, w_uv, w_o):
        B, Sq, M = x.shape[0], x.shape[1], x.shape[2]
        Sk = c_kv.shape[1]
        H, D = w_q.shape[1], w_q.shape[2]
        q = torch.einsum("bqm,mhd->bhqd", x, w_q)
        k = torch.einsum("bkc,chd->bhkd", c_kv, w_uk)
        v = torch.einsum("bkc,chd->bhkd", c_kv, w_uv)
        scores = torch.einsum("bhqd,bhkd->bhqk", q, k) * (D ** -0.5)
        off = Sk - Sq
        qi = torch.arange(Sq)[:, None]
        kj = torch.arange(Sk)[None, :]
        cmask = kj <= (qi + off)
        scores = torch.where(cmask[None, None], scores, -1e9)
        p = _softmax(scores, axis=-1)
        ctx = torch.einsum("bhqk,bhkd->bhqd", p, v)
        return torch.einsum("bhqd,hdm->bqm", ctx, w_o)

    def _B_ref(x, k_cache, v_cache, wq, wo):
        B, Sq, D = x.shape
        Hq, Dh = 32, 128
        Hkv, Sk = k_cache.shape[1], k_cache.shape[2]
        W = min(4096, max(256, Sk // 4))
        rep = Hq // Hkv
        q = (lambda x, *d: x.permute(*d))((x @ wq).reshape(B, Sq, Hq, Dh), 0, 2, 1, 3)
        k = (lambda x, n, axis: torch.repeat_interleave(x, n, dim=axis))(k_cache[:, :, Sk - W:, :], rep, axis=1)
        v = (lambda x, n, axis: torch.repeat_interleave(x, n, dim=axis))(v_cache[:, :, Sk - W:, :], rep, axis=1)
        scores = torch.einsum("bhqd,bhkd->bhqk", q, k) * (Dh ** -0.5)
        p = _softmax(scores, axis=-1)
        o = torch.einsum("bhqk,bhkd->bhqd", p, v)
        return (lambda x, *d: x.permute(*d))(o, 0, 2, 1, 3).reshape(B, Sq, Hq * Dh) @ wo

    a = _A_ref(A_x, A_c_kv, A_w_q, A_w_uk, A_w_uv, A_w_o)
    b = _B_ref(B_x, B_k_cache, B_v_cache, B_wq, B_wo)
    return torch.concatenate([a, b], axis=-1)
```

```asm
; @launch grid=(256,1,1) block=(512,1,1) lds=163840
.amdgcn_target "amdgcn-amd-amdhsa--gfx950"
.text
.globl concat_heads__compressed_kv_cla__sliding_block_cached__decode_kernel
.p2align 8
.type concat_heads__compressed_kv_cla__sliding_block_cached__decode_kernel,@function
concat_heads__compressed_kv_cla__sliding_block_cached__decode_kernel:
  s_cmp_ge_u32 s2, 256
  s_cbranch_scc1 L_end
  s_load_dwordx16 s[16:31], s[0:1], 0
  s_load_dwordx8 s[32:39], s[0:1], 64
  s_load_dwordx4 s[40:43], s[0:1], 96
  s_getpc_b64 s[56:57]
L_pc0:
  s_sub_u32 s56, s56, L_pc0-concat_heads__compressed_kv_cla__sliding_block_cached__decode_kernel
  s_subb_u32 s57, s57, 0
  s_mov_b32 s58, L_code_end-concat_heads__compressed_kv_cla__sliding_block_cached__decode_kernel
  s_mov_b32 s59, 0x20000
  s_lshr_b32 s12, s2, 3
  s_and_b32 s12, s12, 7
  s_lshl_b32 s12, s12, 13
  v_lshlrev_b32 v252, 4, v0
  buffer_load_dwordx4 v[248:251], v252, s[56:59], s12 offen
  v_lshrrev_b32 v1, 6, v0
  v_and_b32 v0, 63, v0
  v_readfirstlane_b32 s3, v1
  s_and_b32 s4, s2, 7
  s_lshr_b32 s5, s2, 3
  s_and_b32 s5, s5, 15
  s_lshr_b32 s6, s5, 2
  s_lshl_b32 s7, s4, 2
  s_add_u32 s6, s6, s7
  s_and_b32 s7, s5, 3
  s_mov_b32 s8, 0xff
  s_mov_b32 s9, 0x00010001
  s_mov_b32 s10, 0x05040100
  s_mov_b32 s11, 0x07060302
  s_lshr_b32 s100, s2, 7
  s_lshl_b32 s100, s100, 2
  s_add_u32 s100, s100, s7
  s_cmp_lg_u32 s3, 4
  s_cbranch_scc1 L_disp
  s_waitcnt lgkmcnt(0)
  s_add_u32 s44, s42, 0
  s_addc_u32 s45, s43, 0
  s_mov_b32 s46, 7864320
  s_mov_b32 s47, 0x20000
  s_load_dword s60, s[44:45], 0
  v_and_b32 v4, 15, v0
  v_lshrrev_b32 v5, 4, v0
  v_lshlrev_b32 v6, 4, v0
  s_mov_b32 s96, 133136
  s_cmp_ge_u32 s2, 128
  s_cselect_b32 s96, 163788, s96
  s_mov_b32 s48, s20
  s_mov_b32 s49, s21
  s_mov_b32 s50, 4194304
  s_mov_b32 s51, 0x20000
  s_mov_b32 s52, s16
  s_mov_b32 s53, s17
  s_mov_b32 s54, 4096
  s_mov_b32 s55, 0x20000
  v_lshlrev_b32 v7, 16, v5
  v_lshl_add_u32 v7, v4, 4, v7
  v_lshrrev_b32 v8, 2, v4
  v_lshlrev_b32 v8, 10, v8
  v_lshl_add_u32 v8, v5, 4, v8
  s_lshl_b32 s12, s100, 7
  buffer_load_dwordx4 v[16:19], v8, s[52:55], s12 offen offset:0
  buffer_load_dwordx4 v[20:23], v8, s[52:55], s12 offen offset:64
  s_lshl_b32 s92, s100, 19
  s_lshl_b32 s14, s6, 8
  s_add_u32 s92, s92, s14
  buffer_load_dwordx4 v[64:67], v7, s[48:51], s92 offen nt
  s_add_u32 s92, s92, 8192
  buffer_load_dwordx4 v[68:71], v7, s[48:51], s92 offen nt
  s_add_u32 s92, s92, 8192
  buffer_load_dwordx4 v[72:75], v7, s[48:51], s92 offen nt
  s_add_u32 s92, s92, 8192
  buffer_load_dwordx4 v[76:79], v7, s[48:51], s92 offen nt
  s_add_u32 s92, s92, 8192
  buffer_load_dwordx4 v[80:83], v7, s[48:51], s92 offen nt
  s_add_u32 s92, s92, 8192
  buffer_load_dwordx4 v[84:87], v7, s[48:51], s92 offen nt
  s_add_u32 s92, s92, 8192
  buffer_load_dwordx4 v[88:91], v7, s[48:51], s92 offen nt
  s_add_u32 s92, s92, 8192
  buffer_load_dwordx4 v[92:95], v7, s[48:51], s92 offen nt
  s_add_u32 s92, s92, 204800
  buffer_load_dwordx4 v[96:99], v7, s[48:51], s92 offen nt
  s_add_u32 s92, s92, 8192
  buffer_load_dwordx4 v[100:103], v7, s[48:51], s92 offen nt
  s_add_u32 s92, s92, 8192
  buffer_load_dwordx4 v[104:107], v7, s[48:51], s92 offen nt
  s_add_u32 s92, s92, 8192
  buffer_load_dwordx4 v[108:111], v7, s[48:51], s92 offen nt
  s_add_u32 s92, s92, 8192
  buffer_load_dwordx4 v[112:115], v7, s[48:51], s92 offen nt
  s_add_u32 s92, s92, 8192
  buffer_load_dwordx4 v[116:119], v7, s[48:51], s92 offen nt
  s_add_u32 s92, s92, 8192
  buffer_load_dwordx4 v[120:123], v7, s[48:51], s92 offen nt
  s_add_u32 s92, s92, 8192
  buffer_load_dwordx4 v[124:127], v7, s[48:51], s92 offen nt
  s_barrier
  s_waitcnt lgkmcnt(0)
  s_add_u32 s60, s60, 1
  s_and_b32 s61, s60, 0xff
  s_xor_b32 s62, s61, 0xa5
  s_lshr_b32 s63, s60, 8
  s_and_b32 s63, s63, 0xff
  s_xor_b32 s63, s63, 0x96
  s_lshr_b32 s64, s60, 16
  s_and_b32 s64, s64, 0xff
  s_xor_b32 s64, s64, s61
  s_xor_b32 s64, s64, 0x3c
  s_lshr_b32 s12, s61, 0
  s_and_b32 s12, s12, 1
  s_lshr_b32 s13, s61, 1
  s_and_b32 s13, s13, 1
  s_lshl_b32 s13, s13, 16
  s_or_b32 s65, s12, s13
  s_lshr_b32 s12, s61, 2
  s_and_b32 s12, s12, 1
  s_lshr_b32 s13, s61, 3
  s_and_b32 s13, s13, 1
  s_lshl_b32 s13, s13, 16
  s_or_b32 s66, s12, s13
  s_lshr_b32 s12, s61, 4
  s_and_b32 s12, s12, 1
  s_lshr_b32 s13, s61, 5
  s_and_b32 s13, s13, 1
  s_lshl_b32 s13, s13, 16
  s_or_b32 s67, s12, s13
  s_lshr_b32 s12, s61, 6
  s_and_b32 s12, s12, 1
  s_lshr_b32 s13, s61, 7
  s_and_b32 s13, s13, 1
  s_lshl_b32 s13, s13, 16
  s_or_b32 s68, s12, s13
  s_lshl_b32 s93, s6, 3
  s_add_u32 s93, s93, s100
  s_lshl_b32 s93, s93, 11
  s_add_u32 s93, s93, 7340032
  s_waitcnt vmcnt(8)
  v_perm_b32 v192, v68, v64, s10
  v_perm_b32 v196, v68, v64, s11
  v_perm_b32 v193, v76, v72, s10
  v_perm_b32 v197, v76, v72, s11
  v_perm_b32 v194, v84, v80, s10
  v_perm_b32 v198, v84, v80, s11
  v_perm_b32 v195, v92, v88, s10
  v_perm_b32 v199, v92, v88, s11
  v_perm_b32 v200, v69, v65, s10
  v_perm_b32 v204, v69, v65, s11
  v_perm_b32 v201, v77, v73, s10
  v_perm_b32 v205, v77, v73, s11
  v_perm_b32 v202, v85, v81, s10
  v_perm_b32 v206, v85, v81, s11
  v_perm_b32 v203, v93, v89, s10
  v_perm_b32 v207, v93, v89, s11
  v_perm_b32 v208, v70, v66, s10
  v_perm_b32 v212, v70, v66, s11
  v_perm_b32 v209, v78, v74, s10
  v_perm_b32 v213, v78, v74, s11
  v_perm_b32 v210, v86, v82, s10
  v_perm_b32 v214, v86, v82, s11
  v_perm_b32 v211, v94, v90, s10
  v_perm_b32 v215, v94, v90, s11
  v_perm_b32 v216, v71, v67, s10
  v_perm_b32 v220, v71, v67, s11
  v_perm_b32 v217, v79, v75, s10
  v_perm_b32 v221, v79, v75, s11
  v_perm_b32 v218, v87, v83, s10
  v_perm_b32 v222, v87, v83, s11
  v_perm_b32 v219, v95, v91, s10
  v_perm_b32 v223, v95, v91, s11
  v_mfma_f32_16x16x32_bf16 v[224:227], v[16:19], v[192:195], 0
  v_mfma_f32_16x16x32_bf16 v[228:231], v[16:19], v[196:199], 0
  v_mfma_f32_16x16x32_bf16 v[232:235], v[16:19], v[200:203], 0
  v_mfma_f32_16x16x32_bf16 v[236:239], v[16:19], v[204:207], 0
  v_mfma_f32_16x16x32_bf16 v[240:243], v[16:19], v[208:211], 0
  v_mfma_f32_16x16x32_bf16 v[244:247], v[16:19], v[212:215], 0
  v_mfma_f32_16x16x32_bf16 v[248:251], v[16:19], v[216:219], 0
  v_mfma_f32_16x16x32_bf16 v[252:255], v[16:19], v[220:223], 0
  s_waitcnt vmcnt(0)
  v_perm_b32 v64, v100, v96, s10
  v_perm_b32 v68, v100, v96, s11
  v_perm_b32 v65, v108, v104, s10
  v_perm_b32 v69, v108, v104, s11
  v_perm_b32 v66, v116, v112, s10
  v_perm_b32 v70, v116, v112, s11
  v_perm_b32 v67, v124, v120, s10
  v_perm_b32 v71, v124, v120, s11
  v_perm_b32 v72, v101, v97, s10
  v_perm_b32 v76, v101, v97, s11
  v_perm_b32 v73, v109, v105, s10
  v_perm_b32 v77, v109, v105, s11
  v_perm_b32 v74, v117, v113, s10
  v_perm_b32 v78, v117, v113, s11
  v_perm_b32 v75, v125, v121, s10
  v_perm_b32 v79, v125, v121, s11
  v_perm_b32 v80, v102, v98, s10
  v_perm_b32 v84, v102, v98, s11
  v_perm_b32 v81, v110, v106, s10
  v_perm_b32 v85, v110, v106, s11
  v_perm_b32 v82, v118, v114, s10
  v_perm_b32 v86, v118, v114, s11
  v_perm_b32 v83, v126, v122, s10
  v_perm_b32 v87, v126, v122, s11
  v_perm_b32 v88, v103, v99, s10
  v_perm_b32 v92, v103, v99, s11
  v_perm_b32 v89, v111, v107, s10
  v_perm_b32 v93, v111, v107, s11
  v_perm_b32 v90, v119, v115, s10
  v_perm_b32 v94, v119, v115, s11
  v_perm_b32 v91, v127, v123, s10
  v_perm_b32 v95, v127, v123, s11
  v_mfma_f32_16x16x32_bf16 v[224:227], v[20:23], v[64:67], v[224:227]
  v_mfma_f32_16x16x32_bf16 v[228:231], v[20:23], v[68:71], v[228:231]
  v_mfma_f32_16x16x32_bf16 v[232:235], v[20:23], v[72:75], v[232:235]
  v_mfma_f32_16x16x32_bf16 v[236:239], v[20:23], v[76:79], v[236:239]
  v_mfma_f32_16x16x32_bf16 v[240:243], v[20:23], v[80:83], v[240:243]
  v_mfma_f32_16x16x32_bf16 v[244:247], v[20:23], v[84:87], v[244:247]
  v_mfma_f32_16x16x32_bf16 v[248:251], v[20:23], v[88:91], v[248:251]
  v_mfma_f32_16x16x32_bf16 v[252:255], v[20:23], v[92:95], v[252:255]
  v_mov_b32 v24, s61
  v_mov_b32 v25, s62
  v_mov_b32 v26, s63
  v_mov_b32 v27, s64
  v_bfi_b32 v16, s8, v24, v224
  v_bfi_b32 v17, s8, v25, v228
  v_bfi_b32 v18, s8, v26, v232
  v_bfi_b32 v19, s8, v27, v236
  v_bfi_b32 v20, s8, v24, v240
  v_bfi_b32 v21, s8, v25, v244
  v_bfi_b32 v22, s8, v26, v248
  v_bfi_b32 v23, s8, v27, v252
  buffer_store_dwordx4 v[16:19], v6, s[44:47], s93 offen offset:0 sc1
  buffer_store_dwordx4 v[20:23], v6, s[44:47], s93 offen offset:1024 sc1
  s_cmp_ge_u32 s2, 128
  s_cbranch_scc1 L_xg
  s_branch L_yab
L_disp:
  s_cmp_ge_u32 s2, 128
  s_cbranch_scc1 L_acu
  s_cmp_eq_u32 s3, 5
  s_cbranch_scc1 L_f2
  s_cmp_lt_u32 s3, 4
  s_cbranch_scc1 L_attb
  s_cmp_eq_u32 s3, 6
  s_cbranch_scc1 L_g1
  s_branch L_w7b
L_acu:
  s_cmp_lt_u32 s3, 4
  s_cbranch_scc1 L_atta
  s_cmp_eq_u32 s3, 5
  s_cbranch_scc1 L_ya
  s_cmp_eq_u32 s3, 6
  s_cbranch_scc1 L_alpha
  s_branch L_w7a
L_f2:
  s_nop 1
  s_waitcnt lgkmcnt(0)
  s_add_u32 s44, s42, 0
  s_addc_u32 s45, s43, 0
  s_mov_b32 s46, 7864320
  s_mov_b32 s47, 0x20000
  s_load_dword s60, s[44:45], 0
  v_and_b32 v4, 15, v0
  v_lshrrev_b32 v5, 4, v0
  v_lshlrev_b32 v6, 4, v0
  s_mov_b32 s48, s22
  s_mov_b32 s49, s23
  s_mov_b32 s50, 4194304
  s_mov_b32 s51, 0x20000
  v_lshlrev_b32 v7, 13, v5
  v_lshl_add_u32 v7, v4, 4, v7
  s_lshl_b32 s95, s7, 20
  s_lshl_b32 s14, s6, 8
  s_add_u32 s95, s95, s14
  v_xor_b32 v44, v4, v5
  v_lshlrev_b32 v44, 4, v44
  v_lshl_add_u32 v44, v4, 11, v44
  v_lshrrev_b32 v45, 3, v4
  v_lshlrev_b32 v45, 14, v45
  v_add_u32 v44, v44, v45
  v_add_u32 v44, 16384, v44
  v_xor_b32 v45, 64, v44
  v_xor_b32 v46, 128, v44
  v_xor_b32 v47, 192, v44
  s_barrier
  s_mov_b32 m0, 16384
  s_nop 0
  buffer_load_dwordx4 v7, s[48:51], s95 offen nt lds
  s_add_u32 s95, s95, 32768
  s_mov_b32 m0, 17408
  s_nop 0
  buffer_load_dwordx4 v7, s[48:51], s95 offen nt lds
  s_add_u32 s95, s95, 32768
  s_mov_b32 m0, 18432
  v_xor_b32 v8, 16, v7
  buffer_load_dwordx4 v8, s[48:51], s95 offen nt lds
  s_add_u32 s95, s95, 32768
  s_mov_b32 m0, 19456
  v_xor_b32 v8, 16, v7
  buffer_load_dwordx4 v8, s[48:51], s95 offen nt lds
  s_add_u32 s95, s95, 32768
  s_mov_b32 m0, 20480
  v_xor_b32 v8, 32, v7
  buffer_load_dwordx4 v8, s[48:51], s95 offen nt lds
  s_add_u32 s95, s95, 32768
  s_mov_b32 m0, 21504
  v_xor_b32 v8, 32, v7
  buffer_load_dwordx4 v8, s[48:51], s95 offen nt lds
  s_add_u32 s95, s95, 32768
  s_mov_b32 m0, 22528
  v_xor_b32 v8, 48, v7
  buffer_load_dwordx4 v8, s[48:51], s95 offen nt lds
  s_add_u32 s95, s95, 32768
  s_mov_b32 m0, 23552
  v_xor_b32 v8, 48, v7
  buffer_load_dwordx4 v8, s[48:51], s95 offen nt lds
  s_add_u32 s95, s95, 32768
  s_mov_b32 m0, 24576
  v_xor_b32 v8, 64, v7
  buffer_load_dwordx4 v8, s[48:51], s95 offen nt lds
  s_add_u32 s95, s95, 32768
  s_mov_b32 m0, 25600
  v_xor_b32 v8, 64, v7
  buffer_load_dwordx4 v8, s[48:51], s95 offen nt lds
  s_add_u32 s95, s95, 32768
  s_mov_b32 m0, 26624
  v_xor_b32 v8, 80, v7
  buffer_load_dwordx4 v8, s[48:51], s95 offen nt lds
  s_add_u32 s95, s95, 32768
  s_mov_b32 m0, 27648
  v_xor_b32 v8, 80, v7
  buffer_load_dwordx4 v8, s[48:51], s95 offen nt lds
  s_add_u32 s95, s95, 32768
  s_mov_b32 m0, 28672
  v_xor_b32 v8, 96, v7
  buffer_load_dwordx4 v8, s[48:51], s95 offen nt lds
  s_add_u32 s95, s95, 32768
  s_mov_b32 m0, 29696
  v_xor_b32 v8, 96, v7
  buffer_load_dwordx4 v8, s[48:51], s95 offen nt lds
  s_add_u32 s95, s95, 32768
  s_mov_b32 m0, 30720
  v_xor_b32 v8, 112, v7
  buffer_load_dwordx4 v8, s[48:51], s95 offen nt lds
  s_add_u32 s95, s95, 32768
  s_mov_b32 m0, 31744
  v_xor_b32 v8, 112, v7
  buffer_load_dwordx4 v8, s[48:51], s95 offen nt lds
  s_add_u32 s95, s95, 32768
  s_mov_b32 m0, 49152
  v_xor_b32 v8, 128, v7
  buffer_load_dwordx4 v8, s[48:51], s95 offen nt lds
  s_add_u32 s95, s95, 32768
  s_mov_b32 m0, 50176
  v_xor_b32 v8, 128, v7
  buffer_load_dwordx4 v8, s[48:51], s95 offen nt lds
  s_add_u32 s95, s95, 32768
  s_mov_b32 m0, 51200
  v_xor_b32 v8, 144, v7
  buffer_load_dwordx4 v8, s[48:51], s95 offen nt lds
  s_add_u32 s95, s95, 32768
  s_mov_b32 m0, 52224
  v_xor_b32 v8, 144, v7
  buffer_load_dwordx4 v8, s[48:51], s95 offen nt lds
  s_add_u32 s95, s95, 32768
  s_mov_b32 m0, 53248
  v_xor_b32 v8, 160, v7
  buffer_load_dwordx4 v8, s[48:51], s95 offen nt lds
  s_add_u32 s95, s95, 32768
  s_mov_b32 m0, 54272
  v_xor_b32 v8, 160, v7
  buffer_load_dwordx4 v8, s[48:51], s95 offen nt lds
  s_add_u32 s95, s95, 32768
  s_mov_b32 m0, 55296
  v_xor_b32 v8, 176, v7
  buffer_load_dwordx4 v8, s[48:51], s95 offen nt lds
  s_add_u32 s95, s95, 32768
  s_mov_b32 m0, 56320
  v_xor_b32 v8, 176, v7
  buffer_load_dwordx4 v8, s[48:51], s95 offen nt lds
  s_add_u32 s95, s95, 32768
  s_mov_b32 m0, 57344
  v_xor_b32 v8, 192, v7
  buffer_load_dwordx4 v8, s[48:51], s95 offen nt lds
  s_add_u32 s95, s95, 32768
  s_mov_b32 m0, 58368
  v_xor_b32 v8, 192, v7
  buffer_load_dwordx4 v8, s[48:51], s95 offen nt lds
  s_add_u32 s95, s95, 32768
  s_mov_b32 m0, 59392
  v_xor_b32 v8, 208, v7
  buffer_load_dwordx4 v8, s[48:51], s95 offen nt lds
  s_add_u32 s95, s95, 32768
  s_mov_b32 m0, 60416
  v_xor_b32 v8, 208, v7
  buffer_load_dwordx4 v8, s[48:51], s95 offen nt lds
  s_add_u32 s95, s95, 32768
  s_mov_b32 m0, 61440
  v_xor_b32 v8, 224, v7
  buffer_load_dwordx4 v8, s[48:51], s95 offen nt lds
  s_add_u32 s95, s95, 32768
  s_mov_b32 m0, 62464
  v_xor_b32 v8, 224, v7
  buffer_load_dwordx4 v8, s[48:51], s95 offen nt lds
  s_add_u32 s95, s95, 32768
  s_mov_b32 m0, 63488
  v_xor_b32 v8, 240, v7
  buffer_load_dwordx4 v8, s[48:51], s95 offen nt lds
  s_add_u32 s95, s95, 32768
  s_mov_b32 m0, 64512
  v_xor_b32 v8, 240, v7
  buffer_load_dwordx4 v8, s[48:51], s95 offen nt lds
  s_waitcnt lgkmcnt(0)
  s_add_u32 s60, s60, 1
  s_and_b32 s61, s60, 0xff
  s_xor_b32 s62, s61, 0xa5
  s_lshr_b32 s63, s60, 8
  s_and_b32 s63, s63, 0xff
  s_xor_b32 s63, s63, 0x96
  s_lshr_b32 s64, s60, 16
  s_and_b32 s64, s64, 0xff
  s_xor_b32 s64, s64, s61
  s_xor_b32 s64, s64, 0x3c
  s_lshr_b32 s12, s61, 0
  s_and_b32 s12, s12, 1
  s_lshr_b32 s13, s61, 1
  s_and_b32 s13, s13, 1
  s_lshl_b32 s13, s13, 16
  s_or_b32 s65, s12, s13
  s_lshr_b32 s12, s61, 2
  s_and_b32 s12, s12, 1
  s_lshr_b32 s13, s61, 3
  s_and_b32 s13, s13, 1
  s_lshl_b32 s13, s13, 16
  s_or_b32 s66, s12, s13
  s_lshr_b32 s12, s61, 4
  s_and_b32 s12, s12, 1
  s_lshr_b32 s13, s61, 5
  s_and_b32 s13, s13, 1
  s_lshl_b32 s13, s13, 16
  s_or_b32 s67, s12, s13
  s_lshr_b32 s12, s61, 6
  s_and_b32 s12, s12, 1
  s_lshr_b32 s13, s61, 7
  s_and_b32 s13, s13, 1
  s_lshl_b32 s13, s13, 16
  s_or_b32 s68, s12, s13
  v_add_u32 v9, 147456, v6
  v_lshrrev_b32 v10, 2, v4
  v_lshlrev_b32 v10, 8, v10
  v_lshl_add_u32 v10, v5, 4, v10
  v_add_u32 v10, 147456, v10
  s_lshl_b32 s92, s6, 14
  s_add_u32 s92, s92, 7340032
  s_add_u32 s93, s92, 4096
  s_add_u32 s98, s92, 8192
  s_add_u32 s99, s92, 12288
  v_lshlrev_b32 v11, 15, v5
  v_lshl_add_u32 v11, v4, 4, v11
  s_lshl_b32 s94, s6, 10
  s_lshl_b32 s13, s7, 8
  s_add_u32 s94, s94, s13
  s_add_u32 s94, s94, 528384
  s_waitcnt vmcnt(0)
  ds_read_b128 v[64:67], v44 offset:0
  ds_read_b128 v[68:71], v45 offset:0
  ds_read_b128 v[72:75], v46 offset:0
  ds_read_b128 v[76:79], v47 offset:0
  ds_read_b128 v[80:83], v44 offset:256
  ds_read_b128 v[84:87], v45 offset:256
  ds_read_b128 v[88:91], v46 offset:256
  ds_read_b128 v[92:95], v47 offset:256
  ds_read_b128 v[96:99], v44 offset:512
  ds_read_b128 v[100:103], v45 offset:512
  ds_read_b128 v[104:107], v46 offset:512
  ds_read_b128 v[108:111], v47 offset:512
  ds_read_b128 v[112:115], v44 offset:768
  ds_read_b128 v[116:119], v45 offset:768
  ds_read_b128 v[120:123], v46 offset:768
  ds_read_b128 v[124:127], v47 offset:768
  ds_read_b128 v[128:131], v44 offset:1024
  ds_read_b128 v[132:135], v45 offset:1024
  ds_read_b128 v[136:139], v46 offset:1024
  ds_read_b128 v[140:143], v47 offset:1024
  ds_read_b128 v[144:147], v44 offset:1280
  ds_read_b128 v[148:151], v45 offset:1280
  ds_read_b128 v[152:155], v46 offset:1280
  ds_read_b128 v[156:159], v47 offset:1280
  ds_read_b128 v[160:163], v44 offset:1536
  ds_read_b128 v[164:167], v45 offset:1536
  ds_read_b128 v[168:171], v46 offset:1536
  ds_read_b128 v[172:175], v47 offset:1536
  ds_read_b128 v[176:179], v44 offset:1792
  ds_read_b128 v[180:183], v45 offset:1792
  ds_read_b128 v[184:187], v46 offset:1792
  ds_read_b128 v[188:191], v47 offset:1792
  s_mov_b32 s69, 0
L_spl_1:
  buffer_load_dwordx4 v[32:35], v6, s[44:47], s92 offen offset:0 sc1
  buffer_load_dwordx4 v[36:39], v6, s[44:47], s92 offen offset:1024 sc1
  buffer_load_dwordx4 v[40:43], v6, s[44:47], s92 offen offset:2048 sc1
  buffer_load_dwordx4 v[44:47], v6, s[44:47], s92 offen offset:3072 sc1
  buffer_load_dwordx4 v[48:51], v6, s[44:47], s93 offen offset:0 sc1
  buffer_load_dwordx4 v[52:55], v6, s[44:47], s93 offen offset:1024 sc1
  buffer_load_dwordx4 v[56:59], v6, s[44:47], s93 offen offset:2048 sc1
  buffer_load_dwordx4 v[60:63], v6, s[44:47], s93 offen offset:3072 sc1
  buffer_load_dwordx4 v[192:195], v6, s[44:47], s98 offen offset:0 sc1
  buffer_load_dwordx4 v[196:199], v6, s[44:47], s98 offen offset:1024 sc1
  buffer_load_dwordx4 v[200:203], v6, s[44:47], s98 offen offset:2048 sc1
  buffer_load_dwordx4 v[204:207], v6, s[44:47], s98 offen offset:3072 sc1
  buffer_load_dwordx4 v[208:211], v6, s[44:47], s99 offen offset:0 sc1
  buffer_load_dwordx4 v[212:215], v6, s[44:47], s99 offen offset:1024 sc1
  buffer_load_dwordx4 v[216:219], v6, s[44:47], s99 offen offset:2048 sc1
  buffer_load_dwordx4 v[220:223], v6, s[44:47], s99 offen offset:3072 sc1
  s_waitcnt vmcnt(15)
  v_xor_b32 v32, s61, v32
  v_xor_b32 v33, s62, v33
  v_xor_b32 v34, s63, v34
  v_xor_b32 v35, s64, v35
  v_or_b32 v1, v32, v33
  v_or3_b32 v1, v1, v34, v35
  v_mov_b32 v16, v32
  v_mov_b32 v17, v33
  v_mov_b32 v18, v34
  v_mov_b32 v19, v35
  s_waitcnt vmcnt(14)
  v_xor_b32 v36, s61, v36
  v_xor_b32 v37, s62, v37
  v_xor_b32 v38, s63, v38
  v_xor_b32 v39, s64, v39
  v_or3_b32 v1, v1, v36, v37
  v_or3_b32 v1, v1, v38, v39
  v_mov_b32 v20, v36
  v_mov_b32 v21, v37
  v_mov_b32 v22, v38
  v_mov_b32 v23, v39
  s_waitcnt vmcnt(13)
  v_xor_b32 v40, s61, v40
  v_xor_b32 v41, s62, v41
  v_xor_b32 v42, s63, v42
  v_xor_b32 v43, s64, v43
  v_or3_b32 v1, v1, v40, v41
  v_or3_b32 v1, v1, v42, v43
  v_add_f32 v16, v16, v40
  v_add_f32 v17, v17, v41
  v_add_f32 v18, v18, v42
  v_add_f32 v19, v19, v43
  s_waitcnt vmcnt(12)
  v_xor_b32 v44, s61, v44
  v_xor_b32 v45, s62, v45
  v_xor_b32 v46, s63, v46
  v_xor_b32 v47, s64, v47
  v_or3_b32 v1, v1, v44, v45
  v_or3_b32 v1, v1, v46, v47
  v_add_f32 v20, v20, v44
  v_add_f32 v21, v21, v45
  v_add_f32 v22, v22, v46
  v_add_f32 v23, v23, v47
  s_waitcnt vmcnt(11)
  v_xor_b32 v48, s61, v48
  v_xor_b32 v49, s62, v49
  v_xor_b32 v50, s63, v50
  v_xor_b32 v51, s64, v51
  v_or3_b32 v1, v1, v48, v49
  v_or3_b32 v1, v1, v50, v51
  v_add_f32 v16, v16, v48
  v_add_f32 v17, v17, v49
  v_add_f32 v18, v18, v50
  v_add_f32 v19, v19, v51
  s_waitcnt vmcnt(10)
  v_xor_b32 v52, s61, v52
  v_xor_b32 v53, s62, v53
  v_xor_b32 v54, s63, v54
  v_xor_b32 v55, s64, v55
  v_or3_b32 v1, v1, v52, v53
  v_or3_b32 v1, v1, v54, v55
  v_add_f32 v20, v20, v52
  v_add_f32 v21, v21, v53
  v_add_f32 v22, v22, v54
  v_add_f32 v23, v23, v55
  s_waitcnt vmcnt(9)
  v_xor_b32 v56, s61, v56
  v_xor_b32 v57, s62, v57
  v_xor_b32 v58, s63, v58
  v_xor_b32 v59, s64, v59
  v_or3_b32 v1, v1, v56, v57
  v_or3_b32 v1, v1, v58, v59
  v_add_f32 v16, v16, v56
  v_add_f32 v17, v17, v57
  v_add_f32 v18, v18, v58
  v_add_f32 v19, v19, v59
  s_waitcnt vmcnt(8)
  v_xor_b32 v60, s61, v60
  v_xor_b32 v61, s62, v61
  v_xor_b32 v62, s63, v62
  v_xor_b32 v63, s64, v63
  v_or3_b32 v1, v1, v60, v61
  v_or3_b32 v1, v1, v62, v63
  v_add_f32 v20, v20, v60
  v_add_f32 v21, v21, v61
  v_add_f32 v22, v22, v62
  v_add_f32 v23, v23, v63
  s_waitcnt vmcnt(7)
  v_xor_b32 v192, s61, v192
  v_xor_b32 v193, s62, v193
  v_xor_b32 v194, s63, v194
  v_xor_b32 v195, s64, v195
  v_or3_b32 v1, v1, v192, v193
  v_or3_b32 v1, v1, v194, v195
  v_add_f32 v16, v16, v192
  v_add_f32 v17, v17, v193
  v_add_f32 v18, v18, v194
  v_add_f32 v19, v19, v195
  s_waitcnt vmcnt(6)
  v_xor_b32 v196, s61, v196
  v_xor_b32 v197, s62, v197
  v_xor_b32 v198, s63, v198
  v_xor_b32 v199, s64, v199
  v_or3_b32 v1, v1, v196, v197
  v_or3_b32 v1, v1, v198, v199
  v_add_f32 v20, v20, v196
  v_add_f32 v21, v21, v197
  v_add_f32 v22, v22, v198
  v_add_f32 v23, v23, v199
  s_waitcnt vmcnt(5)
  v_xor_b32 v200, s61, v200
  v_xor_b32 v201, s62, v201
  v_xor_b32 v202, s63, v202
  v_xor_b32 v203, s64, v203
  v_or3_b32 v1, v1, v200, v201
  v_or3_b32 v1, v1, v202, v203
  v_add_f32 v16, v16, v200
  v_add_f32 v17, v17, v201
  v_add_f32 v18, v18, v202
  v_add_f32 v19, v19, v203
  s_waitcnt vmcnt(4)
  v_xor_b32 v204, s61, v204
  v_xor_b32 v205, s62, v205
  v_xor_b32 v206, s63, v206
  v_xor_b32 v207, s64, v207
  v_or3_b32 v1, v1, v204, v205
  v_or3_b32 v1, v1, v206, v207
  v_add_f32 v20, v20, v204
  v_add_f32 v21, v21, v205
  v_add_f32 v22, v22, v206
  v_add_f32 v23, v23, v207
  s_waitcnt vmcnt(3)
  v_xor_b32 v208, s61, v208
  v_xor_b32 v209, s62, v209
  v_xor_b32 v210, s63, v210
  v_xor_b32 v211, s64, v211
  v_or3_b32 v1, v1, v208, v209
  v_or3_b32 v1, v1, v210, v211
  v_add_f32 v16, v16, v208
  v_add_f32 v17, v17, v209
  v_add_f32 v18, v18, v210
  v_add_f32 v19, v19, v211
  s_waitcnt vmcnt(2)
  v_xor_b32 v212, s61, v212
  v_xor_b32 v213, s62, v213
  v_xor_b32 v214, s63, v214
  v_xor_b32 v215, s64, v215
  v_or3_b32 v1, v1, v212, v213
  v_or3_b32 v1, v1, v214, v215
  v_add_f32 v20, v20, v212
  v_add_f32 v21, v21, v213
  v_add_f32 v22, v22, v214
  v_add_f32 v23, v23, v215
  s_waitcnt vmcnt(1)
  v_xor_b32 v216, s61, v216
  v_xor_b32 v217, s62, v217
  v_xor_b32 v218, s63, v218
  v_xor_b32 v219, s64, v219
  v_or3_b32 v1, v1, v216, v217
  v_or3_b32 v1, v1, v218, v219
  v_add_f32 v16, v16, v216
  v_add_f32 v17, v17, v217
  v_add_f32 v18, v18, v218
  v_add_f32 v19, v19, v219
  s_waitcnt vmcnt(0)
  v_xor_b32 v220, s61, v220
  v_xor_b32 v221, s62, v221
  v_xor_b32 v222, s63, v222
  v_xor_b32 v223, s64, v223
  v_or3_b32 v1, v1, v220, v221
  v_or3_b32 v1, v1, v222, v223
  v_add_f32 v20, v20, v220
  v_add_f32 v21, v21, v221
  v_add_f32 v22, v22, v222
  v_add_f32 v23, v23, v223
  v_and_b32 v1, s8, v1
  v_cmp_ne_u32 vcc, 0, v1
  s_cbranch_vccz L_spd_2
  s_sleep 1
  s_add_u32 s69, s69, 1
  s_cmp_lt_u32 s69, 65536
  s_cbranch_scc1 L_spl_1
  s_mov_b32 s12, s40
  s_mov_b32 s13, s41
  s_mov_b32 s14, 256
  s_mov_b32 s15, 0x20000
  v_mov_b32 v2, 4
  v_mov_b32 v3, s2
  v_or_b32 v3, 0x10000, v3
  buffer_store_dword v3, v2, s[12:15], 0 offen
  s_waitcnt vmcnt(0)
L_spd_2:
  s_nop 1
  v_cvt_pk_bf16_f32 v12, v16, v17
  v_cvt_pk_bf16_f32 v13, v18, v19
  v_cvt_pk_bf16_f32 v14, v20, v21
  v_cvt_pk_bf16_f32 v15, v22, v23
  ds_write_b128 v9, v[12:15]
  ds_read_b128 v[16:19], v10 offset:0
  ds_read_b128 v[20:23], v10 offset:64
  ds_read_b128 v[24:27], v10 offset:128
  ds_read_b128 v[28:31], v10 offset:192
  s_waitcnt lgkmcnt(0)
  v_mfma_f32_16x16x32_bf16 v[224:227], v[16:19], v[64:67], 0
  v_mfma_f32_16x16x32_bf16 v[228:231], v[16:19], v[80:83], 0
  v_mfma_f32_16x16x32_bf16 v[232:235], v[16:19], v[96:99], 0
  v_mfma_f32_16x16x32_bf16 v[236:239], v[16:19], v[112:115], 0
  v_mfma_f32_16x16x32_bf16 v[240:243], v[16:19], v[128:131], 0
  v_mfma_f32_16x16x32_bf16 v[244:247], v[16:19], v[144:147], 0
  v_mfma_f32_16x16x32_bf16 v[248:251], v[16:19], v[160:163], 0
  v_mfma_f32_16x16x32_bf16 v[252:255], v[16:19], v[176:179], 0
  v_mfma_f32_16x16x32_bf16 v[224:227], v[20:23], v[68:71], v[224:227]
  v_mfma_f32_16x16x32_bf16 v[228:231], v[20:23], v[84:87], v[228:231]
  v_mfma_f32_16x16x32_bf16 v[232:235], v[20:23], v[100:103], v[232:235]
  v_mfma_f32_16x16x32_bf16 v[236:239], v[20:23], v[116:119], v[236:239]
  v_mfma_f32_16x16x32_bf16 v[240:243], v[20:23], v[132:135], v[240:243]
  v_mfma_f32_16x16x32_bf16 v[244:247], v[20:23], v[148:151], v[244:247]
  v_mfma_f32_16x16x32_bf16 v[248:251], v[20:23], v[164:167], v[248:251]
  v_mfma_f32_16x16x32_bf16 v[252:255], v[20:23], v[180:183], v[252:255]
  v_mfma_f32_16x16x32_bf16 v[224:227], v[24:27], v[72:75], v[224:227]
  v_mfma_f32_16x16x32_bf16 v[228:231], v[24:27], v[88:91], v[228:231]
  v_mfma_f32_16x16x32_bf16 v[232:235], v[24:27], v[104:107], v[232:235]
  v_mfma_f32_16x16x32_bf16 v[236:239], v[24:27], v[120:123], v[236:239]
  v_mfma_f32_16x16x32_bf16 v[240:243], v[24:27], v[136:139], v[240:243]
  v_mfma_f32_16x16x32_bf16 v[244:247], v[24:27], v[152:155], v[244:247]
  v_mfma_f32_16x16x32_bf16 v[248:251], v[24:27], v[168:171], v[248:251]
  v_mfma_f32_16x16x32_bf16 v[252:255], v[24:27], v[184:187], v[252:255]
  v_mfma_f32_16x16x32_bf16 v[224:227], v[28:31], v[76:79], v[224:227]
  v_mfma_f32_16x16x32_bf16 v[228:231], v[28:31], v[92:95], v[228:231]
  v_mfma_f32_16x16x32_bf16 v[232:235], v[28:31], v[108:111], v[232:235]
  v_mfma_f32_16x16x32_bf16 v[236:239], v[28:31], v[124:127], v[236:239]
  v_mfma_f32_16x16x32_bf16 v[240:243], v[28:31], v[140:143], v[240:243]
  v_mfma_f32_16x16x32_bf16 v[244:247], v[28:31], v[156:159], v[244:247]
  v_mfma_f32_16x16x32_bf16 v[248:251], v[28:31], v[172:175], v[248:251]
  v_mfma_f32_16x16x32_bf16 v[252:255], v[28:31], v[188:191], v[252:255]
  v_mov_b32 v28, s65
  v_mov_b32 v29, s66
  v_mov_b32 v30, s67
  v_mov_b32 v31, s68
  v_add_u32 v16, 0x10000, v224
  v_add_u32 v17, 0x10000, v228
  v_add_u32 v18, 0x10000, v232
  v_add_u32 v19, 0x10000, v236
  v_add_u32 v20, 0x10000, v240
  v_add_u32 v21, 0x10000, v244
  v_add_u32 v22, 0x10000, v248
  v_add_u32 v23, 0x10000, v252
  v_perm_b32 v24, v17, v16, s11
  v_perm_b32 v25, v19, v18, s11
  v_perm_b32 v26, v21, v20, s11
  v_perm_b32 v27, v23, v22, s11
  v_bfi_b32 v24, s9, v28, v24
  v_bfi_b32 v25, s9, v29, v25
  v_bfi_b32 v26, s9, v30, v26
  v_bfi_b32 v27, s9, v31, v27
  buffer_store_dwordx4 v[24:27], v11, s[44:47], s94 offen sc1
  s_barrier
  s_mov_b32 s48, s36
  s_mov_b32 s49, s37
  s_mov_b32 s50, 4194304
  s_mov_b32 s51, 0x20000
  v_lshlrev_b32 v7, 13, v5
  v_lshl_add_u32 v7, v4, 4, v7
  s_lshl_b32 s92, s6, 17
  s_lshl_b32 s12, s7, 8
  s_add_u32 s92, s92, s12
  v_lshlrev_b32 v11, 17, v5
  v_lshl_add_u32 v12, v4, 5, v11
  s_lshl_b32 s93, s4, 14
  s_and_b32 s12, s6, 3
  s_lshl_b32 s12, s12, 10
  s_add_u32 s93, s93, s12
  s_add_u32 s93, s93, 987136
  buffer_load_dword v3, v12, s[44:47], s93 offen
  buffer_load_dword v3, v11, s[44:47], s93 offen offset:512
  s_add_u32 s93, s93, 4096
  buffer_load_dword v3, v12, s[44:47], s93 offen
  buffer_load_dword v3, v11, s[44:47], s93 offen offset:512
  s_add_u32 s93, s93, 4096
  buffer_load_dword v3, v12, s[44:47], s93 offen
  buffer_load_dword v3, v11, s[44:47], s93 offen offset:512
  s_add_u32 s93, s93, 4096
  buffer_load_dword v3, v12, s[44:47], s93 offen
  buffer_load_dword v3, v11, s[44:47], s93 offen offset:512
  v_mov_b32 v60, 133120
  s_mov_b32 s69, 0
L_lspin_3:
  ds_read_b32 v61, v60 offset:8
  s_waitcnt lgkmcnt(0)
  v_cmp_ne_u32 vcc, 4, v61
  s_cbranch_vccz L_ldone_4
  s_add_u32 s69, s69, 1
  s_cmp_lt_u32 s69, 4194304
  s_cbranch_scc1 L_lspin_3
  s_mov_b32 s12, s40
  s_mov_b32 s13, s41
  s_mov_b32 s14, 256
  s_mov_b32 s15, 0x20000
  v_mov_b32 v2, 64
  v_mov_b32 v3, s2
  v_or_b32 v3, 0x10000, v3
  buffer_store_dword v3, v2, s[12:15], 0 offen
  s_waitcnt vmcnt(0)
L_ldone_4:
  s_nop 1
  buffer_load_dwordx4 v[64:67], v7, s[48:51], s92 offen nt
  s_add_u32 s92, s92, 1024
  buffer_load_dwordx4 v[68:71], v7, s[48:51], s92 offen nt
  s_add_u32 s92, s92, 1024
  buffer_load_dwordx4 v[72:75], v7, s[48:51], s92 offen nt
  s_add_u32 s92, s92, 1024
  buffer_load_dwordx4 v[76:79], v7, s[48:51], s92 offen nt
  s_add_u32 s92, s92, 1024
  buffer_load_dwordx4 v[80:83], v7, s[48:51], s92 offen nt
  s_add_u32 s92, s92, 1024
  buffer_load_dwordx4 v[84:87], v7, s[48:51], s92 offen nt
  s_add_u32 s92, s92, 1024
  buffer_load_dwordx4 v[88:91], v7, s[48:51], s92 offen nt
  s_add_u32 s92, s92, 1024
  buffer_load_dwordx4 v[92:95], v7, s[48:51], s92 offen nt
  s_add_u32 s92, s92, 25600
  buffer_load_dwordx4 v[96:99], v7, s[48:51], s92 offen nt
  s_add_u32 s92, s92, 1024
  buffer_load_dwordx4 v[100:103], v7, s[48:51], s92 offen nt
  s_add_u32 s92, s92, 1024
  buffer_load_dwordx4 v[104:107], v7, s[48:51], s92 offen nt
  s_add_u32 s92, s92, 1024
  buffer_load_dwordx4 v[108:111], v7, s[48:51], s92 offen nt
  s_add_u32 s92, s92, 1024
  buffer_load_dwordx4 v[112:115], v7, s[48:51], s92 offen nt
  s_add_u32 s92, s92, 1024
  buffer_load_dwordx4 v[116:119], v7, s[48:51], s92 offen nt
  s_add_u32 s92, s92, 1024
  buffer_load_dwordx4 v[120:123], v7, s[48:51], s92 offen nt
  s_add_u32 s92, s92, 1024
  buffer_load_dwordx4 v[124:127], v7, s[48:51], s92 offen nt
  s_add_u32 s92, s92, 25600
  buffer_load_dwordx4 v[128:131], v7, s[48:51], s92 offen nt
  s_add_u32 s92, s92, 1024
  buffer_load_dwordx4 v[132:135], v7, s[48:51], s92 offen nt
  s_add_u32 s92, s92, 1024
  buffer_load_dwordx4 v[136:139], v7, s[48:51], s92 offen nt
  s_add_u32 s92, s92, 1024
  buffer_load_dwordx4 v[140:143], v7, s[48:51], s92 offen nt
  s_add_u32 s92, s92, 1024
  buffer_load_dwordx4 v[144:147], v7, s[48:51], s92 offen nt
  s_add_u32 s92, s92, 1024
  buffer_load_dwordx4 v[148:151], v7, s[48:51], s92 offen nt
  s_add_u32 s92, s92, 1024
  buffer_load_dwordx4 v[152:155], v7, s[48:51], s92 offen nt
  s_add_u32 s92, s92, 1024
  buffer_load_dwordx4 v[156:159], v7, s[48:51], s92 offen nt
  s_add_u32 s92, s92, 25600
  buffer_load_dwordx4 v[160:163], v7, s[48:51], s92 offen nt
  s_add_u32 s92, s92, 1024
  buffer_load_dwordx4 v[164:167], v7, s[48:51], s92 offen nt
  s_add_u32 s92, s92, 1024
  buffer_load_dwordx4 v[168:171], v7, s[48:51], s92 offen nt
  s_add_u32 s92, s92, 1024
  buffer_load_dwordx4 v[172:175], v7, s[48:51], s92 offen nt
  s_add_u32 s92, s92, 1024
  buffer_load_dwordx4 v[176:179], v7, s[48:51], s92 offen nt
  s_add_u32 s92, s92, 1024
  buffer_load_dwordx4 v[180:183], v7, s[48:51], s92 offen nt
  s_add_u32 s92, s92, 1024
  buffer_load_dwordx4 v[184:187], v7, s[48:51], s92 offen nt
  s_add_u32 s92, s92, 1024
  buffer_load_dwordx4 v[188:191], v7, s[48:51], s92 offen nt
  v_add_u32 v9, 149504, v6
  v_lshrrev_b32 v10, 2, v4
  v_lshlrev_b32 v10, 8, v10
  v_lshl_add_u32 v10, v5, 4, v10
  v_add_u32 v10, 149504, v10
  s_waitcnt vmcnt(24)
  v_perm_b32 v192, v68, v64, s10
  v_perm_b32 v196, v68, v64, s11
  v_perm_b32 v193, v76, v72, s10
  v_perm_b32 v197, v76, v72, s11
  v_perm_b32 v194, v84, v80, s10
  v_perm_b32 v198, v84, v80, s11
  v_perm_b32 v195, v92, v88, s10
  v_perm_b32 v199, v92, v88, s11
  v_perm_b32 v200, v69, v65, s10
  v_perm_b32 v204, v69, v65, s11
  v_perm_b32 v201, v77, v73, s10
  v_perm_b32 v205, v77, v73, s11
  v_perm_b32 v202, v85, v81, s10
  v_perm_b32 v206, v85, v81, s11
  v_perm_b32 v203, v93, v89, s10
  v_perm_b32 v207, v93, v89, s11
  v_perm_b32 v208, v70, v66, s10
  v_perm_b32 v212, v70, v66, s11
  v_perm_b32 v209, v78, v74, s10
  v_perm_b32 v213, v78, v74, s11
  v_perm_b32 v210, v86, v82, s10
  v_perm_b32 v214, v86, v82, s11
  v_perm_b32 v211, v94, v90, s10
  v_perm_b32 v215, v94, v90, s11
  v_perm_b32 v216, v71, v67, s10
  v_perm_b32 v220, v71, v67, s11
  v_perm_b32 v217, v79, v75, s10
  v_perm_b32 v221, v79, v75, s11
  v_perm_b32 v218, v87, v83, s10
  v_perm_b32 v222, v87, v83, s11
  v_perm_b32 v219, v95, v91, s10
  v_perm_b32 v223, v95, v91, s11
  s_waitcnt vmcnt(16)
  v_perm_b32 v64, v100, v96, s10
  v_perm_b32 v68, v100, v96, s11
  v_perm_b32 v65, v108, v104, s10
  v_perm_b32 v69, v108, v104, s11
  v_perm_b32 v66, v116, v112, s10
  v_perm_b32 v70, v116, v112, s11
  v_perm_b32 v67, v124, v120, s10
  v_perm_b32 v71, v124, v120, s11
  v_perm_b32 v72, v101, v97, s10
  v_perm_b32 v76, v101, v97, s11
  v_perm_b32 v73, v109, v105, s10
  v_perm_b32 v77, v109, v105, s11
  v_perm_b32 v74, v117, v113, s10
  v_perm_b32 v78, v117, v113, s11
  v_perm_b32 v75, v125, v121, s10
  v_perm_b32 v79, v125, v121, s11
  v_perm_b32 v80, v102, v98, s10
  v_perm_b32 v84, v102, v98, s11
  v_perm_b32 v81, v110, v106, s10
  v_perm_b32 v85, v110, v106, s11
  v_perm_b32 v82, v118, v114, s10
  v_perm_b32 v86, v118, v114, s11
  v_perm_b32 v83, v126, v122, s10
  v_perm_b32 v87, v126, v122, s11
  v_perm_b32 v88, v103, v99, s10
  v_perm_b32 v92, v103, v99, s11
  v_perm_b32 v89, v111, v107, s10
  v_perm_b32 v93, v111, v107, s11
  v_perm_b32 v90, v119, v115, s10
  v_perm_b32 v94, v119, v115, s11
  v_perm_b32 v91, v127, v123, s10
  v_perm_b32 v95, v127, v123, s11
  s_waitcnt vmcnt(8)
  v_perm_b32 v96, v132, v128, s10
  v_perm_b32 v100, v132, v128, s11
  v_perm_b32 v97, v140, v136, s10
  v_perm_b32 v101, v140, v136, s11
  v_perm_b32 v98, v148, v144, s10
  v_perm_b32 v102, v148, v144, s11
  v_perm_b32 v99, v156, v152, s10
  v_perm_b32 v103, v156, v152, s11
  v_perm_b32 v104, v133, v129, s10
  v_perm_b32 v108, v133, v129, s11
  v_perm_b32 v105, v141, v137, s10
  v_perm_b32 v109, v141, v137, s11
  v_perm_b32 v106, v149, v145, s10
  v_perm_b32 v110, v149, v145, s11
  v_perm_b32 v107, v157, v153, s10
  v_perm_b32 v111, v157, v153, s11
  v_perm_b32 v112, v134, v130, s10
  v_perm_b32 v116, v134, v130, s11
  v_perm_b32 v113, v142, v138, s10
  v_perm_b32 v117, v142, v138, s11
  v_perm_b32 v114, v150, v146, s10
  v_perm_b32 v118, v150, v146, s11
  v_perm_b32 v115, v158, v154, s10
  v_perm_b32 v119, v158, v154, s11
  v_perm_b32 v120, v135, v131, s10
  v_perm_b32 v124, v135, v131, s11
  v_perm_b32 v121, v143, v139, s10
  v_perm_b32 v125, v143, v139, s11
  v_perm_b32 v122, v151, v147, s10
  v_perm_b32 v126, v151, v147, s11
  v_perm_b32 v123, v159, v155, s10
  v_perm_b32 v127, v159, v155, s11
  s_waitcnt vmcnt(0)
  v_perm_b32 v128, v164, v160, s10
  v_perm_b32 v132, v164, v160, s11
  v_perm_b32 v129, v172, v168, s10
  v_perm_b32 v133, v172, v168, s11
  v_perm_b32 v130, v180, v176, s10
  v_perm_b32 v134, v180, v176, s11
  v_perm_b32 v131, v188, v184, s10
  v_perm_b32 v135, v188, v184, s11
  v_perm_b32 v136, v165, v161, s10
  v_perm_b32 v140, v165, v161, s11
  v_perm_b32 v137, v173, v169, s10
  v_perm_b32 v141, v173, v169, s11
  v_perm_b32 v138, v181, v177, s10
  v_perm_b32 v142, v181, v177, s11
  v_perm_b32 v139, v189, v185, s10
  v_perm_b32 v143, v189, v185, s11
  v_perm_b32 v144, v166, v162, s10
  v_perm_b32 v148, v166, v162, s11
  v_perm_b32 v145, v174, v170, s10
  v_perm_b32 v149, v174, v170, s11
  v_perm_b32 v146, v182, v178, s10
  v_perm_b32 v150, v182, v178, s11
  v_perm_b32 v147, v190, v186, s10
  v_perm_b32 v151, v190, v186, s11
  v_perm_b32 v152, v167, v163, s10
  v_perm_b32 v156, v167, v163, s11
  v_perm_b32 v153, v175, v171, s10
  v_perm_b32 v157, v175, v171, s11
  v_perm_b32 v154, v183, v179, s10
  v_perm_b32 v158, v183, v179, s11
  v_perm_b32 v155, v191, v187, s10
  v_perm_b32 v159, v191, v187, s11
  v_lshlrev_b32 v11, 17, v5
  v_lshl_add_u32 v12, v4, 5, v11
  s_lshl_b32 s92, s4, 14
  s_and_b32 s12, s6, 3
  s_lshl_b32 s12, s12, 10
  s_add_u32 s92, s92, s12
  s_add_u32 s92, s92, 987136
  s_add_u32 s93, s92, 4096
  s_add_u32 s94, s92, 8192
  s_add_u32 s95, s92, 12288
  s_lshl_b32 s96, s6, 2
  s_add_u32 s96, s96, s7
  s_lshl_b32 s96, s96, 11
  s_add_u32 s96, s96, 1773568
  s_mov_b32 s69, 0
L_lspin_5:
  ds_read_b32 v61, v60 offset:12
  s_waitcnt lgkmcnt(0)
  v_cmp_ne_u32 vcc, 4, v61
  s_cbranch_vccz L_ldone_6
  s_add_u32 s69, s69, 1
  s_cmp_lt_u32 s69, 4194304
  s_cbranch_scc1 L_lspin_5
  s_mov_b32 s12, s40
  s_mov_b32 s13, s41
  s_mov_b32 s14, 256
  s_mov_b32 s15, 0x20000
  v_mov_b32 v2, 96
  v_mov_b32 v3, s2
  v_or_b32 v3, 0x10000, v3
  buffer_store_dword v3, v2, s[12:15], 0 offen
  s_waitcnt vmcnt(0)
L_ldone_6:
  s_nop 1
  s_mov_b32 s69, 0
L_poll_7:
  buffer_load_dwordx4 v[32:35], v12, s[44:47], s92 offen sc1
  buffer_load_dwordx4 v[36:39], v12, s[44:47], s92 offen offset:16 sc1
  buffer_load_dwordx4 v[40:43], v12, s[44:47], s93 offen sc1
  buffer_load_dwordx4 v[44:47], v12, s[44:47], s93 offen offset:16 sc1
  buffer_load_dwordx4 v[48:51], v12, s[44:47], s94 offen sc1
  buffer_load_dwordx4 v[52:55], v12, s[44:47], s94 offen offset:16 sc1
  buffer_load_dwordx4 v[56:59], v12, s[44:47], s95 offen sc1
  buffer_load_dwordx4 v[60:63], v12, s[44:47], s95 offen offset:16 sc1
  buffer_load_dwordx4 v[16:19], v11, s[44:47], s92 offen offset:512 sc1
  buffer_load_dwordx4 v[20:23], v11, s[44:47], s93 offen offset:512 sc1
  buffer_load_dwordx4 v[24:27], v11, s[44:47], s94 offen offset:512 sc1
  buffer_load_dwordx4 v[28:31], v11, s[44:47], s95 offen offset:512 sc1
  s_waitcnt vmcnt(0)
  v_xor_b32 v32, s61, v32
  v_xor_b32 v33, s62, v33
  v_xor_b32 v34, s63, v34
  v_xor_b32 v35, s64, v35
  v_xor_b32 v36, s61, v36
  v_xor_b32 v37, s62, v37
  v_xor_b32 v38, s63, v38
  v_xor_b32 v39, s64, v39
  v_xor_b32 v40, s61, v40
  v_xor_b32 v41, s62, v41
  v_xor_b32 v42, s63, v42
  v_xor_b32 v43, s64, v43
  v_xor_b32 v44, s61, v44
  v_xor_b32 v45, s62, v45
  v_xor_b32 v46, s63, v46
  v_xor_b32 v47, s64, v47
  v_xor_b32 v48, s61, v48
  v_xor_b32 v49, s62, v49
  v_xor_b32 v50, s63, v50
  v_xor_b32 v51, s64, v51
  v_xor_b32 v52, s61, v52
  v_xor_b32 v53, s62, v53
  v_xor_b32 v54, s63, v54
  v_xor_b32 v55, s64, v55
  v_xor_b32 v56, s61, v56
  v_xor_b32 v57, s62, v57
  v_xor_b32 v58, s63, v58
  v_xor_b32 v59, s64, v59
  v_xor_b32 v60, s61, v60
  v_xor_b32 v61, s62, v61
  v_xor_b32 v62, s63, v62
  v_xor_b32 v63, s64, v63
  v_xor_b32 v16, s61, v16
  v_xor_b32 v17, s62, v17
  v_xor_b32 v18, s63, v18
  v_xor_b32 v19, s64, v19
  v_xor_b32 v20, s61, v20
  v_xor_b32 v21, s62, v21
  v_xor_b32 v22, s63, v22
  v_xor_b32 v23, s64, v23
  v_xor_b32 v24, s61, v24
  v_xor_b32 v25, s62, v25
  v_xor_b32 v26, s63, v26
  v_xor_b32 v27, s64, v27
  v_xor_b32 v28, s61, v28
  v_xor_b32 v29, s62, v29
  v_xor_b32 v30, s63, v30
  v_xor_b32 v31, s64, v31
  v_or_b32 v1, v32, v33
  v_or3_b32 v1, v1, v34, v35
  v_or3_b32 v1, v1, v36, v37
  v_or3_b32 v1, v1, v38, v39
  v_or3_b32 v1, v1, v40, v41
  v_or3_b32 v1, v1, v42, v43
  v_or3_b32 v1, v1, v44, v45
  v_or3_b32 v1, v1, v46, v47
  v_or3_b32 v1, v1, v48, v49
  v_or3_b32 v1, v1, v50, v51
  v_or3_b32 v1, v1, v52, v53
  v_or3_b32 v1, v1, v54, v55
  v_or3_b32 v1, v1, v56, v57
  v_or3_b32 v1, v1, v58, v59
  v_or3_b32 v1, v1, v60, v61
  v_or3_b32 v1, v1, v62, v63
  v_or3_b32 v1, v1, v16, v17
  v_or3_b32 v1, v1, v18, v19
  v_or3_b32 v1, v1, v20, v21
  v_or3_b32 v1, v1, v22, v23
  v_or3_b32 v1, v1, v24, v25
  v_or3_b32 v1, v1, v26, v27
  v_or3_b32 v1, v1, v28, v29
  v_or3_b32 v1, v1, v30, v31
  v_and_b32 v1, s8, v1
  v_cmp_ne_u32 vcc, 0, v1
  s_cbranch_vccz L_done_8
  s_sleep 1
  s_add_u32 s69, s69, 1
  s_cmp_lt_u32 s69, 65536
  s_cbranch_scc1 L_poll_7
  s_mov_b32 s12, s40
  s_mov_b32 s13, s41
  s_mov_b32 s14, 256
  s_mov_b32 s15, 0x20000
  v_mov_b32 v2, 32
  v_mov_b32 v3, s2
  v_or_b32 v3, 0x10000, v3
  buffer_store_dword v3, v2, s[12:15], 0 offen
  s_waitcnt vmcnt(0)
L_done_8:
  s_nop 1
  v_max3_f32 v13, v16, v20, v24
  v_max_f32 v13, v13, v28
  v_sub_f32 v16, v16, v13
  v_sub_f32 v20, v20, v13
  v_sub_f32 v24, v24, v13
  v_sub_f32 v28, v28, v13
  v_exp_f32 v16, v16
  v_exp_f32 v20, v20
  v_exp_f32 v24, v24
  v_exp_f32 v28, v28
  v_mul_f32 v13, v16, v17
  v_fmac_f32 v13, v20, v21
  v_fmac_f32 v13, v24, v25
  v_fmac_f32 v13, v28, v29
  v_rcp_f32 v13, v13
  s_nop 0
  v_mul_f32 v16, v16, v13
  v_mul_f32 v20, v20, v13
  v_mul_f32 v24, v24, v13
  v_mul_f32 v28, v28, v13
  v_mul_f32 v32, v16, v32
  v_fmac_f32 v32, v20, v40
  v_fmac_f32 v32, v24, v48
  v_fmac_f32 v32, v28, v56
  v_mul_f32 v33, v16, v33
  v_fmac_f32 v33, v20, v41
  v_fmac_f32 v33, v24, v49
  v_fmac_f32 v33, v28, v57
  v_mul_f32 v34, v16, v34
  v_fmac_f32 v34, v20, v42
  v_fmac_f32 v34, v24, v50
  v_fmac_f32 v34, v28, v58
  v_mul_f32 v35, v16, v35
  v_fmac_f32 v35, v20, v43
  v_fmac_f32 v35, v24, v51
  v_fmac_f32 v35, v28, v59
  v_mul_f32 v36, v16, v36
  v_fmac_f32 v36, v20, v44
  v_fmac_f32 v36, v24, v52
  v_fmac_f32 v36, v28, v60
  v_mul_f32 v37, v16, v37
  v_fmac_f32 v37, v20, v45
  v_fmac_f32 v37, v24, v53
  v_fmac_f32 v37, v28, v61
  v_mul_f32 v38, v16, v38
  v_fmac_f32 v38, v20, v46
  v_fmac_f32 v38, v24, v54
  v_fmac_f32 v38, v28, v62
  v_mul_f32 v39, v16, v39
  v_fmac_f32 v39, v20, v47
  v_fmac_f32 v39, v24, v55
  v_fmac_f32 v39, v28, v63
  v_mov_b32 v16, v32
  v_mov_b32 v17, v33
  v_mov_b32 v18, v34
  v_mov_b32 v19, v35
  v_mov_b32 v20, v36
  v_mov_b32 v21, v37
  v_mov_b32 v22, v38
  v_mov_b32 v23, v39
  v_cvt_pk_bf16_f32 v12, v16, v17
  v_cvt_pk_bf16_f32 v13, v18, v19
  v_cvt_pk_bf16_f32 v14, v20, v21
  v_cvt_pk_bf16_f32 v15, v22, v23
  ds_write_b128 v9, v[12:15]
  ds_read_b128 v[16:19], v10 offset:0
  ds_read_b128 v[20:23], v10 offset:64
  ds_read_b128 v[24:27], v10 offset:128
  ds_read_b128 v[28:31], v10 offset:192
  s_waitcnt lgkmcnt(0)
  v_mfma_f32_16x16x32_bf16 v[224:227], v[16:19], v[192:195], 0
  v_mfma_f32_16x16x32_bf16 v[228:231], v[16:19], v[196:199], 0
  v_mfma_f32_16x16x32_bf16 v[232:235], v[16:19], v[200:203], 0
  v_mfma_f32_16x16x32_bf16 v[236:239], v[16:19], v[204:207], 0
  v_mfma_f32_16x16x32_bf16 v[240:243], v[16:19], v[208:211], 0
  v_mfma_f32_16x16x32_bf16 v[244:247], v[16:19], v[212:215], 0
  v_mfma_f32_16x16x32_bf16 v[248:251], v[16:19], v[216:219], 0
  v_mfma_f32_16x16x32_bf16 v[252:255], v[16:19], v[220:223], 0
  v_mfma_f32_16x16x32_bf16 v[224:227], v[20:23], v[64:67], v[224:227]
  v_mfma_f32_16x16x32_bf16 v[228:231], v[20:23], v[68:71], v[228:231]
  v_mfma_f32_16x16x32_bf16 v[232:235], v[20:23], v[72:75], v[232:235]
  v_mfma_f32_16x16x32_bf16 v[236:239], v[20:23], v[76:79], v[236:239]
  v_mfma_f32_16x16x32_bf16 v[240:243], v[20:23], v[80:83], v[240:243]
  v_mfma_f32_16x16x32_bf16 v[244:247], v[20:23], v[84:87], v[244:247]
  v_mfma_f32_16x16x32_bf16 v[248:251], v[20:23], v[88:91], v[248:251]
  v_mfma_f32_16x16x32_bf16 v[252:255], v[20:23], v[92:95], v[252:255]
  v_mfma_f32_16x16x32_bf16 v[224:227], v[24:27], v[96:99], v[224:227]
  v_mfma_f32_16x16x32_bf16 v[228:231], v[24:27], v[100:103], v[228:231]
  v_mfma_f32_16x16x32_bf16 v[232:235], v[24:27], v[104:107], v[232:235]
  v_mfma_f32_16x16x32_bf16 v[236:239], v[24:27], v[108:111], v[236:239]
  v_mfma_f32_16x16x32_bf16 v[240:243], v[24:27], v[112:115], v[240:243]
  v_mfma_f32_16x16x32_bf16 v[244:247], v[24:27], v[116:119], v[244:247]
  v_mfma_f32_16x16x32_bf16 v[248:251], v[24:27], v[120:123], v[248:251]
  v_mfma_f32_16x16x32_bf16 v[252:255], v[24:27], v[124:127], v[252:255]
  v_mfma_f32_16x16x32_bf16 v[224:227], v[28:31], v[128:131], v[224:227]
  v_mfma_f32_16x16x32_bf16 v[228:231], v[28:31], v[132:135], v[228:231]
  v_mfma_f32_16x16x32_bf16 v[232:235], v[28:31], v[136:139], v[232:235]
  v_mfma_f32_16x16x32_bf16 v[236:239], v[28:31], v[140:143], v[236:239]
  v_mfma_f32_16x16x32_bf16 v[240:243], v[28:31], v[144:147], v[240:243]
  v_mfma_f32_16x16x32_bf16 v[244:247], v[28:31], v[148:151], v[244:247]
  v_mfma_f32_16x16x32_bf16 v[248:251], v[28:31], v[152:155], v[248:251]
  v_mfma_f32_16x16x32_bf16 v[252:255], v[28:31], v[156:159], v[252:255]
  v_mov_b32 v24, s61
  v_mov_b32 v25, s62
  v_mov_b32 v26, s63
  v_mov_b32 v27, s64
  v_bfi_b32 v16, s8, v24, v224
  v_bfi_b32 v17, s8, v25, v228
  v_bfi_b32 v18, s8, v26, v232
  v_bfi_b32 v19, s8, v27, v236
  v_bfi_b32 v20, s8, v24, v240
  v_bfi_b32 v21, s8, v25, v244
  v_bfi_b32 v22, s8, v26, v248
  v_bfi_b32 v23, s8, v27, v252
  buffer_store_dwordx4 v[16:19], v6, s[44:47], s96 offen offset:0 sc1
  buffer_store_dwordx4 v[20:23], v6, s[44:47], s96 offen offset:1024 sc1
  s_endpgm
L_atta:
  s_nop 1
  s_waitcnt lgkmcnt(0)
  s_add_u32 s44, s42, 0
  s_addc_u32 s45, s43, 0
  s_mov_b32 s46, 7864320
  s_mov_b32 s47, 0x20000
  s_load_dword s60, s[44:45], 0
  s_setprio 2
  s_mov_b32 s48, s18
  s_mov_b32 s49, s19
  s_mov_b32 s50, 16777216
  s_mov_b32 s51, 0x20000
  v_and_b32 v4, 15, v0
  v_lshrrev_b32 v5, 4, v0
  v_lshlrev_b32 v6, 4, v0
  s_lshr_b32 s92, s4, 1
  s_and_b32 s93, s4, 1
  s_lshl_b32 s93, s93, 4
  s_add_u32 s93, s93, s5
  s_lshl_b32 s94, s92, 12
  s_lshl_b32 s12, s93, 7
  s_add_u32 s94, s94, s12
  s_lshl_b32 s12, s3, 5
  s_add_u32 s94, s94, s12
  s_lshl_b32 s94, s94, 10
  s_lshl_b32 s95, s3, 15
  v_mov_b32 v60, 163776
  v_mov_b32 v62, 0
  v_mov_b32 v63, 0
  ds_write_b64 v60, v[62:63]
  ds_write_b64 v60, v[62:63] offset:8
  ds_write_b64 v60, v[62:63] offset:16
  ds_write_b64 v60, v[62:63] offset:24
  s_waitcnt lgkmcnt(0)
  s_barrier
  s_add_u32 m0, s95, 0
  s_add_u32 s12, s94, 0
  buffer_load_dwordx4 v6, s[48:51], s12 offen nt lds
  s_add_u32 m0, s95, 1024
  v_xor_b32 v7, 64, v6
  s_add_u32 s12, s94, 1024
  buffer_load_dwordx4 v7, s[48:51], s12 offen nt lds
  s_add_u32 m0, s95, 2048
  v_xor_b32 v7, 128, v6
  s_add_u32 s12, s94, 2048
  buffer_load_dwordx4 v7, s[48:51], s12 offen nt lds
  s_add_u32 m0, s95, 3072
  v_xor_b32 v7, 192, v6
  s_add_u32 s12, s94, 3072
  buffer_load_dwordx4 v7, s[48:51], s12 offen nt lds
  s_waitcnt lgkmcnt(0)
  s_add_u32 s60, s60, 1
  s_and_b32 s61, s60, 0xff
  s_xor_b32 s62, s61, 0xa5
  s_lshr_b32 s63, s60, 8
  s_and_b32 s63, s63, 0xff
  s_xor_b32 s63, s63, 0x96
  s_lshr_b32 s64, s60, 16
  s_and_b32 s64, s64, 0xff
  s_xor_b32 s64, s64, s61
  s_xor_b32 s64, s64, 0x3c
  s_lshr_b32 s12, s61, 0
  s_and_b32 s12, s12, 1
  s_lshr_b32 s13, s61, 1
  s_and_b32 s13, s13, 1
  s_lshl_b32 s13, s13, 16
  s_or_b32 s65, s12, s13
  s_lshr_b32 s12, s61, 2
  s_and_b32 s12, s12, 1
  s_lshr_b32 s13, s61, 3
  s_and_b32 s13, s13, 1
  s_lshl_b32 s13, s13, 16
  s_or_b32 s66, s12, s13
  s_lshr_b32 s12, s61, 4
  s_and_b32 s12, s12, 1
  s_lshr_b32 s13, s61, 5
  s_and_b32 s13, s13, 1
  s_lshl_b32 s13, s13, 16
  s_or_b32 s67, s12, s13
  s_lshr_b32 s12, s61, 6
  s_and_b32 s12, s12, 1
  s_lshr_b32 s13, s61, 7
  s_and_b32 s13, s13, 1
  s_lshl_b32 s13, s13, 16
  s_or_b32 s68, s12, s13
  s_add_u32 m0, s95, 4096
  v_xor_b32 v7, 16, v6
  s_add_u32 s12, s94, 4096
  buffer_load_dwordx4 v7, s[48:51], s12 offen nt lds
  s_add_u32 m0, s95, 5120
  v_xor_b32 v7, 80, v6
  s_add_u32 s12, s94, 5120
  buffer_load_dwordx4 v7, s[48:51], s12 offen nt lds
  s_add_u32 m0, s95, 6144
  v_xor_b32 v7, 144, v6
  s_add_u32 s12, s94, 6144
  buffer_load_dwordx4 v7, s[48:51], s12 offen nt lds
  s_add_u32 m0, s95, 7168
  v_xor_b32 v7, 208, v6
  s_add_u32 s12, s94, 7168
  buffer_load_dwordx4 v7, s[48:51], s12 offen nt lds
  s_waitcnt vmcnt(7)
  s_add_u32 m0, s95, 8192
  v_xor_b32 v7, 32, v6
  s_add_u32 s12, s94, 8192
  buffer_load_dwordx4 v7, s[48:51], s12 offen nt lds
  s_waitcnt vmcnt(7)
  s_add_u32 m0, s95, 9216
  v_xor_b32 v7, 96, v6
  s_add_u32 s12, s94, 9216
  buffer_load_dwordx4 v7, s[48:51], s12 offen nt lds
  s_waitcnt vmcnt(7)
  s_add_u32 m0, s95, 10240
  v_xor_b32 v7, 160, v6
  s_add_u32 s12, s94, 10240
  buffer_load_dwordx4 v7, s[48:51], s12 offen nt lds
  s_waitcnt vmcnt(7)
  s_add_u32 m0, s95, 11264
  v_xor_b32 v7, 224, v6
  s_add_u32 s12, s94, 11264
  buffer_load_dwordx4 v7, s[48:51], s12 offen nt lds
  s_waitcnt vmcnt(7)
  s_add_u32 m0, s95, 12288
  v_xor_b32 v7, 48, v6
  s_add_u32 s12, s94, 12288
  buffer_load_dwordx4 v7, s[48:51], s12 offen nt lds
  s_waitcnt vmcnt(7)
  s_add_u32 m0, s95, 13312
  v_xor_b32 v7, 112, v6
  s_add_u32 s12, s94, 13312
  buffer_load_dwordx4 v7, s[48:51], s12 offen nt lds
  s_waitcnt vmcnt(7)
  s_add_u32 m0, s95, 14336
  v_xor_b32 v7, 176, v6
  s_add_u32 s12, s94, 14336
  buffer_load_dwordx4 v7, s[48:51], s12 offen nt lds
  s_waitcnt vmcnt(7)
  s_add_u32 m0, s95, 15360
  v_xor_b32 v7, 240, v6
  s_add_u32 s12, s94, 15360
  buffer_load_dwordx4 v7, s[48:51], s12 offen nt lds
  s_waitcnt vmcnt(7)
  s_add_u32 m0, s95, 16384
  s_add_u32 s12, s94, 16384
  buffer_load_dwordx4 v6, s[48:51], s12 offen nt lds
  s_waitcnt vmcnt(7)
  s_add_u32 m0, s95, 17408
  v_xor_b32 v7, 64, v6
  s_add_u32 s12, s94, 17408
  buffer_load_dwordx4 v7, s[48:51], s12 offen nt lds
  s_waitcnt vmcnt(7)
  s_add_u32 m0, s95, 18432
  v_xor_b32 v7, 128, v6
  s_add_u32 s12, s94, 18432
  buffer_load_dwordx4 v7, s[48:51], s12 offen nt lds
  s_waitcnt vmcnt(7)
  s_add_u32 m0, s95, 19456
  v_xor_b32 v7, 192, v6
  s_add_u32 s12, s94, 19456
  buffer_load_dwordx4 v7, s[48:51], s12 offen nt lds
  s_waitcnt vmcnt(7)
  s_mov_b64 exec, 1
  v_mov_b32 v61, 1
  ds_add_u32 v60, v61 offset:16
  s_mov_b64 exec, -1
  s_add_u32 m0, s95, 20480
  v_xor_b32 v7, 16, v6
  s_add_u32 s12, s94, 20480
  buffer_load_dwordx4 v7, s[48:51], s12 offen nt lds
  s_waitcnt vmcnt(7)
  s_add_u32 m0, s95, 21504
  v_xor_b32 v7, 80, v6
  s_add_u32 s12, s94, 21504
  buffer_load_dwordx4 v7, s[48:51], s12 offen nt lds
  s_waitcnt vmcnt(7)
  s_add_u32 m0, s95, 22528
  v_xor_b32 v7, 144, v6
  s_add_u32 s12, s94, 22528
  buffer_load_dwordx4 v7, s[48:51], s12 offen nt lds
  s_waitcnt vmcnt(7)
  s_add_u32 m0, s95, 23552
  v_xor_b32 v7, 208, v6
  s_add_u32 s12, s94, 23552
  buffer_load_dwordx4 v7, s[48:51], s12 offen nt lds
  s_waitcnt vmcnt(7)
  s_add_u32 m0, s95, 24576
  v_xor_b32 v7, 32, v6
  s_add_u32 s12, s94, 24576
  buffer_load_dwordx4 v7, s[48:51], s12 offen nt lds
  s_waitcnt vmcnt(7)
  s_add_u32 m0, s95, 25600
  v_xor_b32 v7, 96, v6
  s_add_u32 s12, s94, 25600
  buffer_load_dwordx4 v7, s[48:51], s12 offen nt lds
  s_waitcnt vmcnt(7)
  s_add_u32 m0, s95, 26624
  v_xor_b32 v7, 160, v6
  s_add_u32 s12, s94, 26624
  buffer_load_dwordx4 v7, s[48:51], s12 offen nt lds
  s_waitcnt vmcnt(7)
  s_add_u32 m0, s95, 27648
  v_xor_b32 v7, 224, v6
  s_add_u32 s12, s94, 27648
  buffer_load_dwordx4 v7, s[48:51], s12 offen nt lds
  s_waitcnt vmcnt(7)
  s_add_u32 m0, s95, 28672
  v_xor_b32 v7, 48, v6
  s_add_u32 s12, s94, 28672
  buffer_load_dwordx4 v7, s[48:51], s12 offen nt lds
  s_waitcnt vmcnt(7)
  s_add_u32 m0, s95, 29696
  v_xor_b32 v7, 112, v6
  s_add_u32 s12, s94, 29696
  buffer_load_dwordx4 v7, s[48:51], s12 offen nt lds
  s_waitcnt vmcnt(7)
  s_add_u32 m0, s95, 30720
  v_xor_b32 v7, 176, v6
  s_add_u32 s12, s94, 30720
  buffer_load_dwordx4 v7, s[48:51], s12 offen nt lds
  s_waitcnt vmcnt(7)
  s_add_u32 m0, s95, 31744
  v_xor_b32 v7, 240, v6
  s_add_u32 s12, s94, 31744
  buffer_load_dwordx4 v7, s[48:51], s12 offen nt lds
  s_mov_b64 exec, 1
  v_mov_b32 v61, 1
  ds_add_u32 v60, v61 offset:0
  s_mov_b64 exec, -1
  s_mov_b64 exec, 1
  v_mov_b32 v61, 1
  ds_add_u32 v60, v61 offset:20
  s_mov_b64 exec, -1
  v_and_b32 v8, 31, v0
  v_lshrrev_b32 v9, 5, v0
  v_and_b32 v10, 3, v0
  v_lshlrev_b32 v10, 2, v10
  v_bfe_u32 v11, v0, 2, 2
  v_or_b32 v10, v10, v11
  v_xor_b32 v10, v10, v9
  v_lshlrev_b32 v10, 4, v10
  v_lshl_add_u32 v10, v8, 10, v10
  v_add_u32 v64, s95, v10
  v_add_u32 v72, 131072, v10
  v_xor_b32 v65, 32, v64
  v_xor_b32 v73, 32, v72
  v_xor_b32 v66, 64, v64
  v_xor_b32 v74, 64, v72
  v_xor_b32 v67, 96, v64
  v_xor_b32 v75, 96, v72
  v_xor_b32 v68, 128, v64
  v_xor_b32 v76, 128, v72
  v_xor_b32 v69, 160, v64
  v_xor_b32 v77, 160, v72
  v_xor_b32 v70, 192, v64
  v_xor_b32 v78, 192, v72
  v_xor_b32 v71, 224, v64
  v_xor_b32 v79, 224, v72
  s_lshl_b32 s96, s92, 5
  s_lshl_b32 s12, s3, 3
  s_add_u32 s96, s96, s12
  s_lshl_b32 s96, s96, 10
  s_add_u32 s96, s96, 528384
  s_add_u32 s97, s96, 4096
  s_and_b32 s12, s3, 1
  s_lshl_b32 s12, s12, 5
  v_xor_b32 v12, s12, v6
  s_lshl_b32 s13, s3, 13
  s_add_u32 s13, s13, 131072
  v_add_u32 v12, s13, v12
  v_xor_b32 v48, 0, v12
  v_xor_b32 v49, 64, v12
  v_xor_b32 v50, 128, v12
  v_xor_b32 v51, 192, v12
  v_xor_b32 v52, 16, v12
  v_xor_b32 v53, 80, v12
  v_xor_b32 v54, 144, v12
  v_xor_b32 v55, 208, v12
  s_waitcnt vmcnt(0)
  s_cmp_lg_u32 s3, 3
  s_cbranch_scc1 L_notw3_9
  s_mov_b32 s69, 0
L_lspin_10:
  ds_read_b32 v61, v60 offset:20
  s_waitcnt lgkmcnt(0)
  v_cmp_ne_u32 vcc, 5, v61
  s_cbranch_vccz L_ldone_11
  s_add_u32 s69, s69, 1
  s_cmp_lt_u32 s69, 4194304
  s_cbranch_scc1 L_lspin_10
  s_mov_b32 s12, s40
  s_mov_b32 s13, s41
  s_mov_b32 s14, 256
  s_mov_b32 s15, 0x20000
  v_mov_b32 v2, 104
  v_mov_b32 v3, s2
  v_or_b32 v3, 0x10000, v3
  buffer_store_dword v3, v2, s[12:15], 0 offen
  s_waitcnt vmcnt(0)
L_ldone_11:
  s_nop 1
L_notw3_9:
  s_nop 1
  ds_read_b128 v[128:131], v64 offset:0
  ds_read_b128 v[132:135], v65 offset:0
  ds_read_b128 v[136:139], v66 offset:0
  ds_read_b128 v[140:143], v67 offset:0
  ds_read_b128 v[144:147], v68 offset:0
  ds_read_b128 v[148:151], v69 offset:0
  ds_read_b128 v[152:155], v70 offset:0
  ds_read_b128 v[156:159], v71 offset:0
  ds_read_b128 v[160:163], v64 offset:256
  ds_read_b128 v[164:167], v65 offset:256
  ds_read_b128 v[168:171], v66 offset:256
  ds_read_b128 v[172:175], v67 offset:256
  ds_read_b128 v[176:179], v68 offset:256
  ds_read_b128 v[180:183], v69 offset:256
  ds_read_b128 v[184:187], v70 offset:256
  ds_read_b128 v[188:191], v71 offset:256
  ds_read_b128 v[192:195], v64 offset:512
  ds_read_b128 v[196:199], v65 offset:512
  ds_read_b128 v[200:203], v66 offset:512
  ds_read_b128 v[204:207], v67 offset:512
  ds_read_b128 v[208:211], v68 offset:512
  ds_read_b128 v[212:215], v69 offset:512
  ds_read_b128 v[216:219], v70 offset:512
  ds_read_b128 v[220:223], v71 offset:512
  ds_read_b128 v[224:227], v64 offset:768
  ds_read_b128 v[228:231], v65 offset:768
  ds_read_b128 v[232:235], v66 offset:768
  ds_read_b128 v[236:239], v67 offset:768
  ds_read_b128 v[240:243], v68 offset:768
  ds_read_b128 v[244:247], v69 offset:768
  ds_read_b128 v[248:251], v70 offset:768
  ds_read_b128 v[252:255], v71 offset:768
  s_mov_b32 s69, 0
L_spl_12:
  buffer_load_dwordx4 v[16:19], v6, s[44:47], s96 offen offset:0 sc1
  buffer_load_dwordx4 v[20:23], v6, s[44:47], s96 offen offset:1024 sc1
  buffer_load_dwordx4 v[24:27], v6, s[44:47], s96 offen offset:2048 sc1
  buffer_load_dwordx4 v[28:31], v6, s[44:47], s96 offen offset:3072 sc1
  buffer_load_dwordx4 v[32:35], v6, s[44:47], s97 offen offset:0 sc1
  buffer_load_dwordx4 v[36:39], v6, s[44:47], s97 offen offset:1024 sc1
  buffer_load_dwordx4 v[40:43], v6, s[44:47], s97 offen offset:2048 sc1
  buffer_load_dwordx4 v[44:47], v6, s[44:47], s97 offen offset:3072 sc1
  s_waitcnt vmcnt(7)
  v_xor_b32 v16, s65, v16
  v_xor_b32 v17, s66, v17
  v_xor_b32 v18, s67, v18
  v_xor_b32 v19, s68, v19
  v_or_b32 v1, v16, v17
  v_or3_b32 v1, v1, v18, v19
  ds_write_b128 v48, v[16:19] offset:0
  s_waitcnt vmcnt(6)
  v_xor_b32 v20, s65, v20
  v_xor_b32 v21, s66, v21
  v_xor_b32 v22, s67, v22
  v_xor_b32 v23, s68, v23
  v_or3_b32 v1, v1, v20, v21
  v_or3_b32 v1, v1, v22, v23
  ds_write_b128 v49, v[20:23] offset:1024
  s_waitcnt vmcnt(5)
  v_xor_b32 v24, s65, v24
  v_xor_b32 v25, s66, v25
  v_xor_b32 v26, s67, v26
  v_xor_b32 v27, s68, v27
  v_or3_b32 v1, v1, v24, v25
  v_or3_b32 v1, v1, v26, v27
  ds_write_b128 v50, v[24:27] offset:2048
  s_waitcnt vmcnt(4)
  v_xor_b32 v28, s65, v28
  v_xor_b32 v29, s66, v29
  v_xor_b32 v30, s67, v30
  v_xor_b32 v31, s68, v31
  v_or3_b32 v1, v1, v28, v29
  v_or3_b32 v1, v1, v30, v31
  ds_write_b128 v51, v[28:31] offset:3072
  s_waitcnt vmcnt(3)
  v_xor_b32 v32, s65, v32
  v_xor_b32 v33, s66, v33
  v_xor_b32 v34, s67, v34
  v_xor_b32 v35, s68, v35
  v_or3_b32 v1, v1, v32, v33
  v_or3_b32 v1, v1, v34, v35
  ds_write_b128 v52, v[32:35] offset:4096
  s_waitcnt vmcnt(2)
  v_xor_b32 v36, s65, v36
  v_xor_b32 v37, s66, v37
  v_xor_b32 v38, s67, v38
  v_xor_b32 v39, s68, v39
  v_or3_b32 v1, v1, v36, v37
  v_or3_b32 v1, v1, v38, v39
  ds_write_b128 v53, v[36:39] offset:5120
  s_waitcnt vmcnt(1)
  v_xor_b32 v40, s65, v40
  v_xor_b32 v41, s66, v41
  v_xor_b32 v42, s67, v42
  v_xor_b32 v43, s68, v43
  v_or3_b32 v1, v1, v40, v41
  v_or3_b32 v1, v1, v42, v43
  ds_write_b128 v54, v[40:43] offset:6144
  s_waitcnt vmcnt(0)
  v_xor_b32 v44, s65, v44
  v_xor_b32 v45, s66, v45
  v_xor_b32 v46, s67, v46
  v_xor_b32 v47, s68, v47
  v_or3_b32 v1, v1, v44, v45
  v_or3_b32 v1, v1, v46, v47
  ds_write_b128 v55, v[44:47] offset:7168
  v_and_b32 v1, s9, v1
  v_cmp_ne_u32 vcc, 0, v1
  s_cbranch_vccz L_spd_13
  s_sleep 1
  s_add_u32 s69, s69, 1
  s_cmp_lt_u32 s69, 65536
  s_cbranch_scc1 L_spl_12
  s_mov_b32 s12, s40
  s_mov_b32 s13, s41
  s_mov_b32 s14, 256
  s_mov_b32 s15, 0x20000
  v_mov_b32 v2, 12
  v_mov_b32 v3, s2
  v_or_b32 v3, 0x10000, v3
  buffer_store_dword v3, v2, s[12:15], 0 offen
  s_waitcnt vmcnt(0)
L_spd_13:
  s_nop 1
  s_waitcnt lgkmcnt(0)
  s_barrier
  ds_read_b128 v[80:83], v72 offset:0
  ds_read_b128 v[84:87], v73 offset:0
  ds_read_b128 v[88:91], v74 offset:0
  ds_read_b128 v[92:95], v75 offset:0
  ds_read_b128 v[96:99], v76 offset:0
  s_waitcnt lgkmcnt(4)
  v_mfma_f32_32x32x16_bf16 v[112:127], v[128:131], v[80:83], 0
  ds_read_b128 v[100:103], v77 offset:0
  s_waitcnt lgkmcnt(4)
  v_mfma_f32_32x32x16_bf16 v[112:127], v[132:135], v[84:87], v[112:127]
  ds_read_b128 v[104:107], v78 offset:0
  s_waitcnt lgkmcnt(4)
  v_mfma_f32_32x32x16_bf16 v[112:127], v[136:139], v[88:91], v[112:127]
  s_lshl_b32 s99, s4, 19
  s_lshl_b32 s12, s5, 15
  s_add_u32 s99, s99, s12
  s_lshl_b32 s12, s3, 7
  s_add_u32 s99, s99, s12
  s_add_u32 s99, s99, 2098176
  v_lshlrev_b32 v14, 11, v4
  buffer_load_dword v3, v14, s[44:47], s99 offen
  ds_read_b128 v[108:111], v79 offset:0
  s_waitcnt lgkmcnt(4)
  v_mfma_f32_32x32x16_bf16 v[112:127], v[140:143], v[92:95], v[112:127]
  ds_read_b128 v[80:83], v72 offset:256
  s_waitcnt lgkmcnt(4)
  v_mfma_f32_32x32x16_bf16 v[112:127], v[144:147], v[96:99], v[112:127]
  ds_read_b128 v[84:87], v73 offset:256
  s_waitcnt lgkmcnt(4)
  v_mfma_f32_32x32x16_bf16 v[112:127], v[148:151], v[100:103], v[112:127]
  ds_read_b128 v[88:91], v74 offset:256
  s_waitcnt lgkmcnt(4)
  v_mfma_f32_32x32x16_bf16 v[112:127], v[152:155], v[104:107], v[112:127]
  ds_read_b128 v[92:95], v75 offset:256
  s_waitcnt lgkmcnt(4)
  v_mfma_f32_32x32x16_bf16 v[112:127], v[156:159], v[108:111], v[112:127]
  ds_read_b128 v[96:99], v76 offset:256
  s_waitcnt lgkmcnt(4)
  v_mfma_f32_32x32x16_bf16 v[112:127], v[160:163], v[80:83], v[112:127]
  ds_read_b128 v[100:103], v77 offset:256
  s_waitcnt lgkmcnt(4)
  v_mfma_f32_32x32x16_bf16 v[112:127], v[164:167], v[84:87], v[112:127]
  ds_read_b128 v[104:107], v78 offset:256
  s_waitcnt lgkmcnt(4)
  v_mfma_f32_32x32x16_bf16 v[112:127], v[168:171], v[88:91], v[112:127]
  ds_read_b128 v[108:111], v79 offset:256
  s_waitcnt lgkmcnt(4)
  v_mfma_f32_32x32x16_bf16 v[112:127], v[172:175], v[92:95], v[112:127]
  ds_read_b128 v[80:83], v72 offset:512
  s_waitcnt lgkmcnt(4)
  v_mfma_f32_32x32x16_bf16 v[112:127], v[176:179], v[96:99], v[112:127]
  ds_read_b128 v[84:87], v73 offset:512
  s_waitcnt lgkmcnt(4)
  v_mfma_f32_32x32x16_bf16 v[112:127], v[180:183], v[100:103], v[112:127]
  ds_read_b128 v[88:91], v74 offset:512
  s_waitcnt lgkmcnt(4)
  v_mfma_f32_32x32x16_bf16 v[112:127], v[184:187], v[104:107], v[112:127]
  ds_read_b128 v[92:95], v75 offset:512
  s_waitcnt lgkmcnt(4)
  v_mfma_f32_32x32x16_bf16 v[112:127], v[188:191], v[108:111], v[112:127]
  ds_read_b128 v[96:99], v76 offset:512
  s_waitcnt lgkmcnt(4)
  v_mfma_f32_32x32x16_bf16 v[112:127], v[192:195], v[80:83], v[112:127]
  ds_read_b128 v[100:103], v77 offset:512
  s_waitcnt lgkmcnt(4)
  v_mfma_f32_32x32x16_bf16 v[112:127], v[196:199], v[84:87], v[112:127]
  ds_read_b128 v[104:107], v78 offset:512
  s_waitcnt lgkmcnt(4)
  v_mfma_f32_32x32x16_bf16 v[112:127], v[200:203], v[88:91], v[112:127]
  ds_read_b128 v[108:111], v79 offset:512
  s_waitcnt lgkmcnt(4)
  v_mfma_f32_32x32x16_bf16 v[112:127], v[204:207], v[92:95], v[112:127]
  ds_read_b128 v[80:83], v72 offset:768
  s_waitcnt lgkmcnt(4)
  v_mfma_f32_32x32x16_bf16 v[112:127], v[208:211], v[96:99], v[112:127]
  s_lshl_b32 s12, s3, 2
  s_add_u32 s12, s12, 139264
  v_lshlrev_b32 v18, 4, v8
  v_add_u32 v19, s12, v18
  v_add_u32 v18, 139264, v18
  v_lshlrev_b32 v36, 2, v8
  s_lshl_b32 s12, s3, 8
  v_add_u32 v37, s12, v36
  s_lshl_b32 s12, s3, 11
  s_add_u32 s12, s12, 131072
  v_add_u32 v28, s12, v6
  v_add_u32 v29, 131072, v6
  ds_read_b128 v[84:87], v73 offset:768
  s_waitcnt lgkmcnt(4)
  v_mfma_f32_32x32x16_bf16 v[112:127], v[212:215], v[100:103], v[112:127]
  ds_read_b128 v[88:91], v74 offset:768
  s_waitcnt lgkmcnt(4)
  v_mfma_f32_32x32x16_bf16 v[112:127], v[216:219], v[104:107], v[112:127]
  v_and_b32 v30, 1, v5
  v_lshrrev_b32 v31, 1, v5
  v_lshrrev_b32 v32, 2, v4
  v_and_b32 v33, 3, v0
  v_lshrrev_b32 v34, 1, v33
  v_lshl_add_u32 v34, v30, 1, v34
  ds_read_b128 v[92:95], v75 offset:768
  s_waitcnt lgkmcnt(4)
  v_mfma_f32_32x32x16_bf16 v[112:127], v[220:223], v[108:111], v[112:127]
  v_lshl_add_u32 v35, v32, 2, v31
  v_xor_b32 v34, v34, v35
  v_lshlrev_b32 v34, 4, v34
  v_and_b32 v35, 1, v33
  v_lshl_add_u32 v34, v35, 3, v34
  ds_read_b128 v[96:99], v76 offset:768
  s_waitcnt lgkmcnt(4)
  v_mfma_f32_32x32x16_bf16 v[112:127], v[224:227], v[80:83], v[112:127]
  v_lshl_add_u32 v35, v31, 2, v32
  v_lshl_add_u32 v34, v35, 10, v34
  s_lshl_b32 s12, s3, 8
  v_add_u32 v64, s12, v34
  ds_read_b128 v[100:103], v77 offset:768
  s_waitcnt lgkmcnt(4)
  v_mfma_f32_32x32x16_bf16 v[112:127], v[228:231], v[84:87], v[112:127]
  v_xor_b32 v65, 32, v64
  v_xor_b32 v66, 64, v64
  v_xor_b32 v67, 96, v64
  v_xor_b32 v68, 128, v64
  ds_read_b128 v[104:107], v78 offset:768
  s_waitcnt lgkmcnt(4)
  v_mfma_f32_32x32x16_bf16 v[112:127], v[232:235], v[88:91], v[112:127]
  v_xor_b32 v69, 160, v64
  v_xor_b32 v70, 192, v64
  v_xor_b32 v71, 224, v64
  ds_read_b128 v[108:111], v79 offset:768
  s_waitcnt lgkmcnt(4)
  v_mfma_f32_32x32x16_bf16 v[112:127], v[236:239], v[92:95], v[112:127]
  s_waitcnt lgkmcnt(3)
  v_mfma_f32_32x32x16_bf16 v[112:127], v[240:243], v[96:99], v[112:127]
  ds_read_b64_tr_b16 v[48:49], v64 offset:0
  s_waitcnt lgkmcnt(3)
  v_mfma_f32_32x32x16_bf16 v[112:127], v[244:247], v[100:103], v[112:127]
  ds_read_b64_tr_b16 v[52:53], v66 offset:0
  s_waitcnt lgkmcnt(3)
  v_mfma_f32_32x32x16_bf16 v[112:127], v[248:251], v[104:107], v[112:127]
  ds_read_b64_tr_b16 v[56:57], v68 offset:0
  s_waitcnt lgkmcnt(3)
  v_mfma_f32_32x32x16_bf16 v[112:127], v[252:255], v[108:111], v[112:127]
  ds_read_b64_tr_b16 v[60:61], v70 offset:0
  s_nop 10
  v_max3_f32 v16, v112, v113, v114
  v_max3_f32 v16, v16, v115, v116
  v_max3_f32 v16, v16, v117, v118
  v_max3_f32 v16, v16, v119, v120
  v_max3_f32 v16, v16, v121, v122
  v_max3_f32 v16, v16, v123, v124
  v_max3_f32 v16, v16, v125, v126
  v_max_f32 v16, v16, v127
  v_mov_b32 v17, v16
  s_nop 1
  v_permlane32_swap_b32 v16, v17
  v_max_f32 v16, v16, v17
  ds_write_b32 v37, v16
  v_add_u32 v72, 65536, v64
  v_add_u32 v73, 65536, v65
  v_add_u32 v74, 65536, v66
  v_add_u32 v75, 65536, v67
  v_add_u32 v76, 65536, v68
  v_add_u32 v77, 65536, v69
  v_add_u32 v78, 65536, v70
  v_add_u32 v79, 65536, v71
  s_mov_b32 s13, 0x3e0293ee
  s_waitcnt lgkmcnt(0)
  s_barrier
  ds_read2_b32 v[20:21], v36 offset0:0 offset1:64
  ds_read2_b32 v[22:23], v36 offset0:128 offset1:192
  v_mov_b32 v24, 141312
  v_mov_b32 v26, 0
  v_mov_b32 v27, 0
  ds_write_b64 v24, v[26:27]
  ds_write_b64 v24, v[26:27] offset:8
  ds_write_b32 v24, v26 offset:20
  ds_write_b64 v24, v[26:27] offset:24
  s_waitcnt lgkmcnt(4)
  v_max3_f32 v16, v20, v21, v22
  v_max_f32 v16, v16, v23
  v_mul_f32 v16, s13, v16
  v_fma_f32 v112, v112, s13, -v16
  v_fma_f32 v113, v113, s13, -v16
  v_fma_f32 v114, v114, s13, -v16
  v_fma_f32 v115, v115, s13, -v16
  v_fma_f32 v116, v116, s13, -v16
  v_fma_f32 v117, v117, s13, -v16
  v_fma_f32 v118, v118, s13, -v16
  v_fma_f32 v119, v119, s13, -v16
  v_fma_f32 v120, v120, s13, -v16
  v_fma_f32 v121, v121, s13, -v16
  v_fma_f32 v122, v122, s13, -v16
  v_fma_f32 v123, v123, s13, -v16
  v_fma_f32 v124, v124, s13, -v16
  v_fma_f32 v125, v125, s13, -v16
  v_fma_f32 v126, v126, s13, -v16
  v_fma_f32 v127, v127, s13, -v16
  v_exp_f32 v112, v112
  v_exp_f32 v113, v113
  v_exp_f32 v114, v114
  v_exp_f32 v115, v115
  v_exp_f32 v116, v116
  v_exp_f32 v117, v117
  v_exp_f32 v118, v118
  v_exp_f32 v119, v119
  v_exp_f32 v120, v120
  v_exp_f32 v121, v121
  v_exp_f32 v122, v122
  v_exp_f32 v123, v123
  v_exp_f32 v124, v124
  v_exp_f32 v125, v125
  v_exp_f32 v126, v126
  v_exp_f32 v127, v127
  v_cvt_pk_bf16_f32 v96, v112, v113
  v_cvt_pk_bf16_f32 v97, v114, v115
  v_cvt_pk_bf16_f32 v98, v116, v117
  v_cvt_pk_bf16_f32 v99, v118, v119
  v_cvt_pk_bf16_f32 v100, v120, v121
  v_cvt_pk_bf16_f32 v101, v122, v123
  v_cvt_pk_bf16_f32 v102, v124, v125
  v_cvt_pk_bf16_f32 v103, v126, v127
  ds_write_b128 v28, v[96:99]
  ds_write_b128 v28, v[100:103] offset:1024
  v_add_f32 v26, v112, v113
  v_add_f32 v27, v114, v115
  v_add_f32 v26, v26, v116
  v_add_f32 v27, v27, v117
  v_add_f32 v26, v26, v118
  v_add_f32 v27, v27, v119
  v_add_f32 v26, v26, v120
  v_add_f32 v27, v27, v121
  v_add_f32 v26, v26, v122
  v_add_f32 v27, v27, v123
  v_add_f32 v26, v26, v124
  v_add_f32 v27, v27, v125
  v_add_f32 v26, v26, v126
  v_add_f32 v27, v27, v127
  v_add_f32 v26, v26, v27
  v_mov_b32 v27, v26
  s_nop 1
  v_permlane32_swap_b32 v26, v27
  v_add_f32 v26, v26, v27
  ds_write_b32 v19, v26 offset:1024
  v_mov_b32 v45, 141328
  s_waitcnt lgkmcnt(0)
  s_barrier
  ds_read_b128 v[192:195], v29 offset:0
  ds_read_b64_tr_b16 v[50:51], v65 offset:8192
  ds_read_b128 v[196:199], v29 offset:1024
  ds_read_b64_tr_b16 v[228:229], v64 offset:16384
  ds_read_b64_tr_b16 v[230:231], v65 offset:24576
  ds_read_b128 v[200:203], v29 offset:2048
  ds_read_b64_tr_b16 v[232:233], v64 offset:32768
  ds_read_b64_tr_b16 v[234:235], v65 offset:40960
  ds_read_b128 v[204:207], v29 offset:3072
  ds_read_b64_tr_b16 v[236:237], v64 offset:49152
  ds_read_b64_tr_b16 v[238:239], v65 offset:57344
  ds_read_b128 v[208:211], v29 offset:4096
  ds_read_b64_tr_b16 v[240:241], v72 offset:0
  ds_read_b64_tr_b16 v[242:243], v73 offset:8192
  ds_read_b128 v[212:215], v29 offset:5120
  ds_read_b64_tr_b16 v[244:245], v72 offset:16384
  ds_read_b64_tr_b16 v[246:247], v73 offset:24576
  ds_read_b128 v[216:219], v29 offset:6144
  ds_read_b128 v[220:223], v29 offset:7168
  ds_read_b128 v[20:23], v18 offset:1024
  ds_read_b32 v44, v45
  ds_read_b64_tr_b16 v[248:249], v72 offset:32768
  ds_read_b64_tr_b16 v[250:251], v73 offset:40960
  s_waitcnt lgkmcnt(15)
  v_mfma_f32_32x32x16_bf16 v[128:143], v[48:51], v[192:195], 0
  ds_read_b64_tr_b16 v[252:253], v72 offset:49152
  ds_read_b64_tr_b16 v[254:255], v73 offset:57344
  s_waitcnt lgkmcnt(15)
  v_mfma_f32_32x32x16_bf16 v[128:143], v[228:231], v[196:199], v[128:143]
  s_waitcnt lgkmcnt(4)
  v_readfirstlane_b32 s98, v44
  ds_read_b64_tr_b16 v[54:55], v67 offset:8192
  s_waitcnt lgkmcnt(15)
  v_mfma_f32_32x32x16_bf16 v[128:143], v[232:235], v[200:203], v[128:143]
  s_waitcnt lgkmcnt(6)
  s_cmp_lg_u32 s3, 0
  s_cbranch_scc1 L_noml_14
  v_add_f32 v24, v20, v21
  v_add_f32 v25, v22, v23
  v_add_f32 v25, v24, v25
  v_mov_b32 v24, v16
  v_mov_b32 v26, 0
  v_mov_b32 v27, 0
  v_mov_b32 v36, s61
  v_mov_b32 v37, s62
  v_mov_b32 v38, s63
  v_mov_b32 v39, s64
  v_bfi_b32 v24, s8, v36, v24
  v_bfi_b32 v25, s8, v37, v25
  v_bfi_b32 v26, s8, v38, v26
  v_bfi_b32 v27, s8, v39, v27
  s_lshl_b32 s12, s92, 5
  s_add_u32 s12, s12, s93
  s_lshl_b32 s12, s12, 9
  s_add_u32 s12, s12, 659456
  v_cmp_gt_u32 vcc, 32, v0
  s_nop 1
  s_and_saveexec_b64 s[14:15], vcc
  s_cmp_eq_u32 s98, 1
  s_cbranch_scc0 L_mlslow_15
  buffer_store_dwordx4 v[24:27], v6, s[44:47], s12 offen
  s_branch L_mlend_16
L_mlslow_15:
  buffer_store_dwordx4 v[24:27], v6, s[44:47], s12 offen sc1
L_mlend_16:
  s_mov_b64 exec, s[14:15]
L_noml_14:
  s_nop 1
  ds_read_b64_tr_b16 v[228:229], v66 offset:16384
  ds_read_b64_tr_b16 v[230:231], v67 offset:24576
  s_waitcnt lgkmcnt(15)
  v_mfma_f32_32x32x16_bf16 v[128:143], v[236:239], v[204:207], v[128:143]
  v_mov_b32 v40, s65
  v_mov_b32 v41, s66
  v_mov_b32 v42, s67
  v_mov_b32 v43, s68
  ds_read_b64_tr_b16 v[232:233], v66 offset:32768
  ds_read_b64_tr_b16 v[234:235], v67 offset:40960
  s_waitcnt lgkmcnt(15)
  v_mfma_f32_32x32x16_bf16 v[128:143], v[240:243], v[208:211], v[128:143]
  s_lshl_b32 s97, s4, 19
  s_lshl_b32 s12, s3, 17
  s_add_u32 s97, s97, s12
  s_lshl_b32 s12, s5, 11
  s_add_u32 s97, s97, s12
  s_add_u32 s97, s97, 2097152
  ds_read_b64_tr_b16 v[236:237], v66 offset:49152
  ds_read_b64_tr_b16 v[238:239], v67 offset:57344
  s_waitcnt lgkmcnt(15)
  v_mfma_f32_32x32x16_bf16 v[128:143], v[244:247], v[212:215], v[128:143]
  ds_read_b64_tr_b16 v[240:241], v74 offset:0
  ds_read_b64_tr_b16 v[242:243], v75 offset:8192
  s_waitcnt lgkmcnt(11)
  v_mfma_f32_32x32x16_bf16 v[128:143], v[248:251], v[216:219], v[128:143]
  ds_read_b64_tr_b16 v[244:245], v74 offset:16384
  ds_read_b64_tr_b16 v[246:247], v75 offset:24576
  s_waitcnt lgkmcnt(11)
  v_mfma_f32_32x32x16_bf16 v[128:143], v[252:255], v[220:223], v[128:143]
  ds_read_b64_tr_b16 v[248:249], v74 offset:32768
  ds_read_b64_tr_b16 v[250:251], v75 offset:40960
  s_waitcnt lgkmcnt(12)
  v_mfma_f32_32x32x16_bf16 v[144:159], v[52:55], v[192:195], 0
  ds_read_b64_tr_b16 v[252:253], v74 offset:49152
  ds_read_b64_tr_b16 v[254:255], v75 offset:57344
  s_waitcnt lgkmcnt(12)
  v_mfma_f32_32x32x16_bf16 v[144:159], v[228:231], v[196:199], v[144:159]
  ds_read_b64_tr_b16 v[58:59], v69 offset:8192
  s_waitcnt lgkmcnt(11)
  v_mfma_f32_32x32x16_bf16 v[144:159], v[232:235], v[200:203], v[144:159]
  ds_read_b64_tr_b16 v[228:229], v68 offset:16384
  ds_read_b64_tr_b16 v[230:231], v69 offset:24576
  s_waitcnt lgkmcnt(11)
  v_mfma_f32_32x32x16_bf16 v[144:159], v[236:239], v[204:207], v[144:159]
  v_cvt_pk_bf16_f32 v16, v128, v129
  v_cvt_pk_bf16_f32 v17, v130, v131
  v_bfi_b32 v16, s9, v40, v16
  v_bfi_b32 v17, s9, v41, v17
  ds_read_b64_tr_b16 v[232:233], v68 offset:32768
  ds_read_b64_tr_b16 v[234:235], v69 offset:40960
  s_waitcnt lgkmcnt(11)
  v_mfma_f32_32x32x16_bf16 v[144:159], v[240:243], v[208:211], v[144:159]
  v_cvt_pk_bf16_f32 v18, v132, v133
  v_cvt_pk_bf16_f32 v19, v134, v135
  v_bfi_b32 v18, s9, v42, v18
  v_bfi_b32 v19, s9, v43, v19
  ds_read_b64_tr_b16 v[236:237], v68 offset:49152
  ds_read_b64_tr_b16 v[238:239], v69 offset:57344
  s_waitcnt lgkmcnt(11)
  v_mfma_f32_32x32x16_bf16 v[144:159], v[244:247], v[212:215], v[144:159]
  v_cvt_pk_bf16_f32 v20, v136, v137
  v_cvt_pk_bf16_f32 v21, v138, v139
  v_bfi_b32 v20, s9, v40, v20
  v_bfi_b32 v21, s9, v41, v21
  ds_read_b64_tr_b16 v[240:241], v76 offset:0
  ds_read_b64_tr_b16 v[242:243], v77 offset:8192
  s_waitcnt lgkmcnt(11)
  v_mfma_f32_32x32x16_bf16 v[144:159], v[248:251], v[216:219], v[144:159]
  v_cvt_pk_bf16_f32 v22, v140, v141
  v_cvt_pk_bf16_f32 v23, v142, v143
  v_bfi_b32 v22, s9, v42, v22
  v_bfi_b32 v23, s9, v43, v23
  ds_read_b64_tr_b16 v[244:245], v76 offset:16384
  ds_read_b64_tr_b16 v[246:247], v77 offset:24576
  s_waitcnt lgkmcnt(11)
  v_mfma_f32_32x32x16_bf16 v[144:159], v[252:255], v[220:223], v[144:159]
  s_cmp_eq_u32 s98, 1
  s_cbranch_scc0 L_slow_17
  buffer_store_dwordx4 v[16:19], v6, s[44:47], s97 offen offset:0
  buffer_store_dwordx4 v[20:23], v6, s[44:47], s97 offen offset:1024
  s_branch L_stend_18
L_slow_17:
  buffer_store_dwordx4 v[16:19], v6, s[44:47], s97 offen offset:0 sc1
  buffer_store_dwordx4 v[20:23], v6, s[44:47], s97 offen offset:1024 sc1
L_stend_18:
  s_add_u32 s97, s97, 32768
  ds_read_b64_tr_b16 v[248:249], v76 offset:32768
  ds_read_b64_tr_b16 v[250:251], v77 offset:40960
  s_waitcnt lgkmcnt(12)
  v_mfma_f32_32x32x16_bf16 v[160:175], v[56:59], v[192:195], 0
  ds_read_b64_tr_b16 v[252:253], v76 offset:49152
  ds_read_b64_tr_b16 v[254:255], v77 offset:57344
  s_waitcnt lgkmcnt(12)
  v_mfma_f32_32x32x16_bf16 v[160:175], v[228:231], v[196:199], v[160:175]
  ds_read_b64_tr_b16 v[62:63], v71 offset:8192
  s_waitcnt lgkmcnt(11)
  v_mfma_f32_32x32x16_bf16 v[160:175], v[232:235], v[200:203], v[160:175]
  ds_read_b64_tr_b16 v[228:229], v70 offset:16384
  ds_read_b64_tr_b16 v[230:231], v71 offset:24576
  s_waitcnt lgkmcnt(11)
  v_mfma_f32_32x32x16_bf16 v[160:175], v[236:239], v[204:207], v[160:175]
  v_cvt_pk_bf16_f32 v24, v144, v145
  v_cvt_pk_bf16_f32 v25, v146, v147
  v_bfi_b32 v24, s9, v40, v24
  v_bfi_b32 v25, s9, v41, v25
  ds_read_b64_tr_b16 v[232:233], v70 offset:32768
  ds_read_b64_tr_b16 v[234:235], v71 offset:40960
  s_waitcnt lgkmcnt(11)
  v_mfma_f32_32x32x16_bf16 v[160:175], v[240:243], v[208:211], v[160:175]
  v_cvt_pk_bf16_f32 v26, v148, v149
  v_cvt_pk_bf16_f32 v27, v150, v151
  v_bfi_b32 v26, s9, v42, v26
  v_bfi_b32 v27, s9, v43, v27
  ds_read_b64_tr_b16 v[236:237], v70 offset:49152
  ds_read_b64_tr_b16 v[238:239], v71 offset:57344
  s_waitcnt lgkmcnt(11)
  v_mfma_f32_32x32x16_bf16 v[160:175], v[244:247], v[212:215], v[160:175]
  v_cvt_pk_bf16_f32 v28, v152, v153
  v_cvt_pk_bf16_f32 v29, v154, v155
  v_bfi_b32 v28, s9, v40, v28
  v_bfi_b32 v29, s9, v41, v29
  ds_read_b64_tr_b16 v[240:241], v78 offset:0
  ds_read_b64_tr_b16 v[242:243], v79 offset:8192
  s_waitcnt lgkmcnt(11)
  v_mfma_f32_32x32x16_bf16 v[160:175], v[248:251], v[216:219], v[160:175]
  v_cvt_pk_bf16_f32 v30, v156, v157
  v_cvt_pk_bf16_f32 v31, v158, v159
  v_bfi_b32 v30, s9, v42, v30
  v_bfi_b32 v31, s9, v43, v31
  ds_read_b64_tr_b16 v[244:245], v78 offset:16384
  ds_read_b64_tr_b16 v[246:247], v79 offset:24576
  s_waitcnt lgkmcnt(11)
  v_mfma_f32_32x32x16_bf16 v[160:175], v[252:255], v[220:223], v[160:175]
  s_cmp_eq_u32 s98, 1
  s_cbranch_scc0 L_slow_19
  buffer_store_dwordx4 v[24:27], v6, s[44:47], s97 offen offset:0
  buffer_store_dwordx4 v[28:31], v6, s[44:47], s97 offen offset:1024
  s_branch L_stend_20
L_slow_19:
  buffer_store_dwordx4 v[24:27], v6, s[44:47], s97 offen offset:0 sc1
  buffer_store_dwordx4 v[28:31], v6, s[44:47], s97 offen offset:1024 sc1
L_stend_20:
  s_add_u32 s97, s97, 32768
  ds_read_b64_tr_b16 v[248:249], v78 offset:32768
  ds_read_b64_tr_b16 v[250:251], v79 offset:40960
  s_waitcnt lgkmcnt(12)
  v_mfma_f32_32x32x16_bf16 v[176:191], v[60:63], v[192:195], 0
  ds_read_b64_tr_b16 v[252:253], v78 offset:49152
  ds_read_b64_tr_b16 v[254:255], v79 offset:57344
  s_waitcnt lgkmcnt(12)
  v_mfma_f32_32x32x16_bf16 v[176:191], v[228:231], v[196:199], v[176:191]
  s_waitcnt lgkmcnt(10)
  v_mfma_f32_32x32x16_bf16 v[176:191], v[232:235], v[200:203], v[176:191]
  s_waitcnt lgkmcnt(8)
  v_mfma_f32_32x32x16_bf16 v[176:191], v[236:239], v[204:207], v[176:191]
  v_cvt_pk_bf16_f32 v16, v160, v161
  v_cvt_pk_bf16_f32 v17, v162, v163
  v_bfi_b32 v16, s9, v40, v16
  v_bfi_b32 v17, s9, v41, v17
  s_waitcnt lgkmcnt(6)
  v_mfma_f32_32x32x16_bf16 v[176:191], v[240:243], v[208:211], v[176:191]
  v_cvt_pk_bf16_f32 v18, v164, v165
  v_cvt_pk_bf16_f32 v19, v166, v167
  v_bfi_b32 v18, s9, v42, v18
  v_bfi_b32 v19, s9, v43, v19
  s_waitcnt lgkmcnt(4)
  v_mfma_f32_32x32x16_bf16 v[176:191], v[244:247], v[212:215], v[176:191]
  v_cvt_pk_bf16_f32 v20, v168, v169
  v_cvt_pk_bf16_f32 v21, v170, v171
  v_bfi_b32 v20, s9, v40, v20
  v_bfi_b32 v21, s9, v41, v21
  s_waitcnt lgkmcnt(2)
  v_mfma_f32_32x32x16_bf16 v[176:191], v[248:251], v[216:219], v[176:191]
  v_cvt_pk_bf16_f32 v22, v172, v173
  v_cvt_pk_bf16_f32 v23, v174, v175
  v_bfi_b32 v22, s9, v42, v22
  v_bfi_b32 v23, s9, v43, v23
  s_waitcnt lgkmcnt(0)
  v_mfma_f32_32x32x16_bf16 v[176:191], v[252:255], v[220:223], v[176:191]
  s_cmp_eq_u32 s98, 1
  s_cbranch_scc0 L_slow_21
  buffer_store_dwordx4 v[16:19], v6, s[44:47], s97 offen offset:0
  buffer_store_dwordx4 v[20:23], v6, s[44:47], s97 offen offset:1024
  s_branch L_stend_22
L_slow_21:
  buffer_store_dwordx4 v[16:19], v6, s[44:47], s97 offen offset:0 sc1
  buffer_store_dwordx4 v[20:23], v6, s[44:47], s97 offen offset:1024 sc1
L_stend_22:
  s_add_u32 s97, s97, 32768
  s_nop 3
  v_cvt_pk_bf16_f32 v24, v176, v177
  v_cvt_pk_bf16_f32 v25, v178, v179
  v_bfi_b32 v24, s9, v40, v24
  v_bfi_b32 v25, s9, v41, v25
  v_cvt_pk_bf16_f32 v26, v180, v181
  v_cvt_pk_bf16_f32 v27, v182, v183
  v_bfi_b32 v26, s9, v42, v26
  v_bfi_b32 v27, s9, v43, v27
  v_cvt_pk_bf16_f32 v28, v184, v185
  v_cvt_pk_bf16_f32 v29, v186, v187
  v_bfi_b32 v28, s9, v40, v28
  v_bfi_b32 v29, s9, v41, v29
  v_cvt_pk_bf16_f32 v30, v188, v189
  v_cvt_pk_bf16_f32 v31, v190, v191
  v_bfi_b32 v30, s9, v42, v30
  v_bfi_b32 v31, s9, v43, v31
  s_cmp_eq_u32 s98, 1
  s_cbranch_scc0 L_slow_23
  buffer_store_dwordx4 v[24:27], v6, s[44:47], s97 offen offset:0
  buffer_store_dwordx4 v[28:31], v6, s[44:47], s97 offen offset:1024
  s_branch L_stend_24
L_slow_23:
  buffer_store_dwordx4 v[24:27], v6, s[44:47], s97 offen offset:0 sc1
  buffer_store_dwordx4 v[28:31], v6, s[44:47], s97 offen offset:1024 sc1
L_stend_24:
  s_add_u32 s97, s97, 32768
  v_mov_b32 v24, 141312
  s_mov_b64 exec, 1
  v_mov_b32 v25, 1
  ds_add_u32 v24, v25 offset:12
  s_mov_b64 exec, -1
  s_lshl_b32 s96, s4, 19
  s_lshl_b32 s12, s5, 15
  s_add_u32 s96, s96, s12
  s_lshl_b32 s12, s3, 7
  s_add_u32 s96, s96, s12
  s_add_u32 s96, s96, 2097152
  s_add_u32 s97, s96, 8192
  s_add_u32 s98, s96, 16384
  s_add_u32 s95, s96, 24576
  v_lshrrev_b32 v21, 3, v4
  v_and_b32 v22, 7, v4
  v_lshlrev_b32 v20, 11, v5
  v_lshl_add_u32 v20, v21, 9, v20
  v_lshl_add_u32 v20, v22, 4, v20
  s_lshl_b32 s12, s3, 5
  s_add_u32 s12, s12, 143360
  v_lshlrev_b32 v19, 7, v5
  v_lshl_add_u32 v19, v22, 2, v19
  v_add_u32 v19, s12, v19
  v_lshrrev_b32 v12, 2, v22
  v_lshlrev_b32 v12, 9, v12
  v_lshl_add_u32 v12, v5, 7, v12
  v_lshl_add_u32 v12, v21, 6, v12
  v_and_b32 v13, 3, v22
  v_lshl_add_u32 v12, v13, 4, v12
  s_lshl_b32 s99, s4, 4
  s_add_u32 s99, s99, s5
  s_lshl_b32 s99, s99, 12
  s_lshl_b32 s12, s3, 10
  s_add_u32 s99, s99, s12
  s_add_u32 s99, s99, 6553600
  v_mov_b32 v36, s61
  v_mov_b32 v37, s62
  v_mov_b32 v38, s63
  v_mov_b32 v39, s64
  v_lshrrev_b32 v23, 2, v0
  v_lshlrev_b32 v23, 11, v23
  v_and_b32 v13, 3, v0
  v_lshl_add_u32 v23, v13, 4, v23
  s_mov_b32 s69, 0
L_poll_25:
  buffer_load_dwordx4 v[40:43], v23, s[44:47], s96 offen offset:1024 sc1
  s_waitcnt vmcnt(0)
  v_xor_b32 v40, s65, v40
  v_xor_b32 v41, s66, v41
  v_xor_b32 v42, s67, v42
  v_xor_b32 v43, s68, v43
  v_or_b32 v1, v40, v41
  v_or3_b32 v1, v1, v42, v43
  v_and_b32 v1, s9, v1
  v_cmp_ne_u32 vcc, 0, v1
  s_cbranch_vccz L_done_26
  s_sleep 1
  s_add_u32 s69, s69, 1
  s_cmp_lt_u32 s69, 65536
  s_cbranch_scc1 L_poll_25
  s_mov_b32 s12, s40
  s_mov_b32 s13, s41
  s_mov_b32 s14, 256
  s_mov_b32 s15, 0x20000
  v_mov_b32 v2, 140
  v_mov_b32 v3, s2
  v_or_b32 v3, 0x10000, v3
  buffer_store_dword v3, v2, s[12:15], 0 offen
  s_waitcnt vmcnt(0)
L_done_26:
  s_nop 1
  buffer_load_dwordx4 v[128:131], v20, s[44:47], s96 offen offset:0 sc1
  buffer_load_dwordx4 v[132:135], v20, s[44:47], s96 offen offset:1024 sc1
  buffer_load_dwordx4 v[136:139], v20, s[44:47], s97 offen offset:0 sc1
  buffer_load_dwordx4 v[140:143], v20, s[44:47], s97 offen offset:1024 sc1
  buffer_load_dwordx4 v[144:147], v20, s[44:47], s98 offen offset:0 sc1
  buffer_load_dwordx4 v[148:151], v20, s[44:47], s98 offen offset:1024 sc1
  buffer_load_dwordx4 v[152:155], v20, s[44:47], s95 offen offset:0 sc1
  buffer_load_dwordx4 v[156:159], v20, s[44:47], s95 offen offset:1024 sc1
  s_mov_b32 s69, 0
L_lspin_27:
  ds_read_b32 v27, v24 offset:8
  s_waitcnt lgkmcnt(0)
  v_cmp_ne_u32 vcc, 1, v27
  s_cbranch_vccz L_ldone_28
  s_add_u32 s69, s69, 1
  s_cmp_lt_u32 s69, 4194304
  s_cbranch_scc1 L_lspin_27
  s_mov_b32 s12, s40
  s_mov_b32 s13, s41
  s_mov_b32 s14, 256
  s_mov_b32 s15, 0x20000
  v_mov_b32 v2, 48
  v_mov_b32 v3, s2
  v_or_b32 v3, 0x10000, v3
  buffer_store_dword v3, v2, s[12:15], 0 offen
  s_waitcnt vmcnt(0)
L_ldone_28:
  s_nop 1
  ds_read_b32 v28, v19 offset:0
  ds_read_b32 v29, v19 offset:512
  ds_read_b32 v30, v19 offset:1024
  ds_read_b32 v31, v19 offset:1536
  s_waitcnt lgkmcnt(0)
  v_lshlrev_b32 v32, 16, v28
  v_lshlrev_b32 v33, 16, v29
  v_lshlrev_b32 v34, 16, v30
  v_lshlrev_b32 v35, 16, v31
  s_mov_b32 s69, 0
L_rll_29:
  v_mov_b32 v160, 0
  v_mov_b32 v161, 0
  v_mov_b32 v162, 0
  v_mov_b32 v163, 0
  v_mov_b32 v164, 0
  v_mov_b32 v165, 0
  v_mov_b32 v166, 0
  v_mov_b32 v167, 0
  v_mov_b32 v168, 0
  v_mov_b32 v169, 0
  v_mov_b32 v170, 0
  v_mov_b32 v171, 0
  v_mov_b32 v172, 0
  v_mov_b32 v173, 0
  v_mov_b32 v174, 0
  v_mov_b32 v175, 0
  s_waitcnt vmcnt(7)
  v_xor_b32 v128, s65, v128
  v_xor_b32 v129, s66, v129
  v_xor_b32 v130, s67, v130
  v_xor_b32 v131, s68, v131
  v_or_b32 v1, v128, v129
  v_or3_b32 v1, v1, v130, v131
  v_dot2c_f32_bf16 v160, v128, v28
  v_dot2c_f32_bf16 v161, v128, v32
  v_dot2c_f32_bf16 v162, v129, v28
  v_dot2c_f32_bf16 v163, v129, v32
  v_dot2c_f32_bf16 v164, v130, v28
  v_dot2c_f32_bf16 v165, v130, v32
  v_dot2c_f32_bf16 v166, v131, v28
  v_dot2c_f32_bf16 v167, v131, v32
  s_waitcnt vmcnt(6)
  v_xor_b32 v132, s65, v132
  v_xor_b32 v133, s66, v133
  v_xor_b32 v134, s67, v134
  v_xor_b32 v135, s68, v135
  v_or3_b32 v1, v1, v132, v133
  v_or3_b32 v1, v1, v134, v135
  v_dot2c_f32_bf16 v168, v132, v28
  v_dot2c_f32_bf16 v169, v132, v32
  v_dot2c_f32_bf16 v170, v133, v28
  v_dot2c_f32_bf16 v171, v133, v32
  v_dot2c_f32_bf16 v172, v134, v28
  v_dot2c_f32_bf16 v173, v134, v32
  v_dot2c_f32_bf16 v174, v135, v28
  v_dot2c_f32_bf16 v175, v135, v32
  s_waitcnt vmcnt(5)
  v_xor_b32 v136, s65, v136
  v_xor_b32 v137, s66, v137
  v_xor_b32 v138, s67, v138
  v_xor_b32 v139, s68, v139
  v_or3_b32 v1, v1, v136, v137
  v_or3_b32 v1, v1, v138, v139
  v_dot2c_f32_bf16 v160, v136, v29
  v_dot2c_f32_bf16 v161, v136, v33
  v_dot2c_f32_bf16 v162, v137, v29
  v_dot2c_f32_bf16 v163, v137, v33
  v_dot2c_f32_bf16 v164, v138, v29
  v_dot2c_f32_bf16 v165, v138, v33
  v_dot2c_f32_bf16 v166, v139, v29
  v_dot2c_f32_bf16 v167, v139, v33
  s_waitcnt vmcnt(4)
  v_xor_b32 v140, s65, v140
  v_xor_b32 v141, s66, v141
  v_xor_b32 v142, s67, v142
  v_xor_b32 v143, s68, v143
  v_or3_b32 v1, v1, v140, v141
  v_or3_b32 v1, v1, v142, v143
  v_dot2c_f32_bf16 v168, v140, v29
  v_dot2c_f32_bf16 v169, v140, v33
  v_dot2c_f32_bf16 v170, v141, v29
  v_dot2c_f32_bf16 v171, v141, v33
  v_dot2c_f32_bf16 v172, v142, v29
  v_dot2c_f32_bf16 v173, v142, v33
  v_dot2c_f32_bf16 v174, v143, v29
  v_dot2c_f32_bf16 v175, v143, v33
  s_waitcnt vmcnt(3)
  v_xor_b32 v144, s65, v144
  v_xor_b32 v145, s66, v145
  v_xor_b32 v146, s67, v146
  v_xor_b32 v147, s68, v147
  v_or3_b32 v1, v1, v144, v145
  v_or3_b32 v1, v1, v146, v147
  v_dot2c_f32_bf16 v160, v144, v30
  v_dot2c_f32_bf16 v161, v144, v34
  v_dot2c_f32_bf16 v162, v145, v30
  v_dot2c_f32_bf16 v163, v145, v34
  v_dot2c_f32_bf16 v164, v146, v30
  v_dot2c_f32_bf16 v165, v146, v34
  v_dot2c_f32_bf16 v166, v147, v30
  v_dot2c_f32_bf16 v167, v147, v34
  s_waitcnt vmcnt(2)
  v_xor_b32 v148, s65, v148
  v_xor_b32 v149, s66, v149
  v_xor_b32 v150, s67, v150
  v_xor_b32 v151, s68, v151
  v_or3_b32 v1, v1, v148, v149
  v_or3_b32 v1, v1, v150, v151
  v_dot2c_f32_bf16 v168, v148, v30
  v_dot2c_f32_bf16 v169, v148, v34
  v_dot2c_f32_bf16 v170, v149, v30
  v_dot2c_f32_bf16 v171, v149, v34
  v_dot2c_f32_bf16 v172, v150, v30
  v_dot2c_f32_bf16 v173, v150, v34
  v_dot2c_f32_bf16 v174, v151, v30
  v_dot2c_f32_bf16 v175, v151, v34
  s_waitcnt vmcnt(1)
  v_xor_b32 v152, s65, v152
  v_xor_b32 v153, s66, v153
  v_xor_b32 v154, s67, v154
  v_xor_b32 v155, s68, v155
  v_or3_b32 v1, v1, v152, v153
  v_or3_b32 v1, v1, v154, v155
  v_dot2c_f32_bf16 v160, v152, v31
  v_dot2c_f32_bf16 v161, v152, v35
  v_dot2c_f32_bf16 v162, v153, v31
  v_dot2c_f32_bf16 v163, v153, v35
  v_dot2c_f32_bf16 v164, v154, v31
  v_dot2c_f32_bf16 v165, v154, v35
  v_dot2c_f32_bf16 v166, v155, v31
  v_dot2c_f32_bf16 v167, v155, v35
  s_waitcnt vmcnt(0)
  v_xor_b32 v156, s65, v156
  v_xor_b32 v157, s66, v157
  v_xor_b32 v158, s67, v158
  v_xor_b32 v159, s68, v159
  v_or3_b32 v1, v1, v156, v157
  v_or3_b32 v1, v1, v158, v159
  v_dot2c_f32_bf16 v168, v156, v31
  v_dot2c_f32_bf16 v169, v156, v35
  v_dot2c_f32_bf16 v170, v157, v31
  v_dot2c_f32_bf16 v171, v157, v35
  v_dot2c_f32_bf16 v172, v158, v31
  v_dot2c_f32_bf16 v173, v158, v35
  v_dot2c_f32_bf16 v174, v159, v31
  v_dot2c_f32_bf16 v175, v159, v35
  v_and_b32 v1, s9, v1
  v_cmp_ne_u32 vcc, 0, v1
  s_cbranch_vccz L_rld_30
  buffer_load_dwordx4 v[128:131], v20, s[44:47], s96 offen offset:0 sc1
  buffer_load_dwordx4 v[132:135], v20, s[44:47], s96 offen offset:1024 sc1
  buffer_load_dwordx4 v[136:139], v20, s[44:47], s97 offen offset:0 sc1
  buffer_load_dwordx4 v[140:143], v20, s[44:47], s97 offen offset:1024 sc1
  buffer_load_dwordx4 v[144:147], v20, s[44:47], s98 offen offset:0 sc1
  buffer_load_dwordx4 v[148:151], v20, s[44:47], s98 offen offset:1024 sc1
  buffer_load_dwordx4 v[152:155], v20, s[44:47], s95 offen offset:0 sc1
  buffer_load_dwordx4 v[156:159], v20, s[44:47], s95 offen offset:1024 sc1
  s_add_u32 s69, s69, 1
  s_cmp_lt_u32 s69, 65536
  s_cbranch_scc1 L_rll_29
  s_mov_b32 s12, s40
  s_mov_b32 s13, s41
  s_mov_b32 s14, 256
  s_mov_b32 s15, 0x20000
  v_mov_b32 v2, 24
  v_mov_b32 v3, s2
  v_or_b32 v3, 0x10000, v3
  buffer_store_dword v3, v2, s[12:15], 0 offen
  s_waitcnt vmcnt(0)
L_rld_30:
  s_nop 3
  v_permlane32_swap_b32 v160, v168
  v_permlane32_swap_b32 v161, v169
  v_permlane32_swap_b32 v162, v170
  v_permlane32_swap_b32 v163, v171
  v_permlane32_swap_b32 v164, v172
  v_permlane32_swap_b32 v165, v173
  v_permlane32_swap_b32 v166, v174
  v_permlane32_swap_b32 v167, v175
  v_add_f32 v160, v160, v168
  v_add_f32 v161, v161, v169
  v_add_f32 v162, v162, v170
  v_add_f32 v163, v163, v171
  v_add_f32 v164, v164, v172
  v_add_f32 v165, v165, v173
  v_add_f32 v166, v166, v174
  v_add_f32 v167, v167, v175
  v_permlane16_swap_b32 v160, v164
  v_permlane16_swap_b32 v161, v165
  v_permlane16_swap_b32 v162, v166
  v_permlane16_swap_b32 v163, v167
  v_add_f32 v160, v160, v164
  v_add_f32 v161, v161, v165
  v_add_f32 v162, v162, v166
  v_add_f32 v163, v163, v167
  v_bfi_b32 v160, s8, v36, v160
  v_bfi_b32 v161, s8, v37, v161
  v_bfi_b32 v162, s8, v38, v162
  v_bfi_b32 v163, s8, v39, v163
  buffer_store_dwordx4 v[160:163], v12, s[44:47], s99 offen sc1
  s_mov_b64 exec, 1
  v_mov_b32 v25, 1
  ds_add_u32 v24, v25 offset:0
  s_mov_b64 exec, -1
  s_cmp_gt_u32 s3, 1
  s_cbranch_scc1 L_nofinal_31
  s_lshl_b32 s12, s4, 4
  s_add_u32 s12, s12, s5
  s_lshr_b32 s92, s12, 5
  s_and_b32 s93, s12, 31
  s_lshl_b32 s93, s93, 1
  s_mul_i32 s94, s3, 262144
  s_add_u32 s94, s94, 1511424
  s_lshl_b32 s12, s92, 11
  s_add_u32 s94, s94, s12
  s_lshl_b32 s12, s93, 4
  s_add_u32 s94, s94, s12
  v_lshrrev_b32 v12, 2, v0
  v_lshlrev_b32 v12, 14, v12
  v_and_b32 v13, 1, v0
  v_lshl_add_u32 v12, v13, 10, v12
  v_bfe_u32 v13, v0, 1, 1
  v_lshl_add_u32 v12, v13, 4, v12
  s_add_u32 s95, s94, 8192
  s_mov_b32 s56, s38
  s_mov_b32 s57, s39
  s_mov_b32 s58, 8192
  s_mov_b32 s59, 0x20000
  s_lshr_b32 s12, s93, 4
  s_lshl_b32 s12, s12, 11
  s_and_b32 s13, s93, 15
  s_lshl_b32 s13, s13, 4
  s_add_u32 s12, s12, s13
  s_lshl_b32 s13, s3, 10
  s_add_u32 s12, s12, s13
  s_lshl_b32 s13, s92, 8
  s_add_u32 s96, s12, s13
  v_and_b32 v13, 1, v0
  v_lshlrev_b32 v13, 3, v13
  v_bfe_u32 v14, v0, 1, 1
  v_lshl_add_u32 v13, v14, 4, v13
  buffer_load_dword v3, v12, s[44:47], s94 offen
  buffer_load_dword v3, v12, s[44:47], s95 offen
  buffer_load_dword v3, v13, s[56:59], s96 offen
  v_mov_b32 v14, 0
  buffer_load_dword v3, v14, s[44:47], 0 offen
  s_mov_b32 s69, 0
L_lspin_32:
  ds_read_b32 v27, v24 offset:24
  s_waitcnt lgkmcnt(0)
  v_cmp_ne_u32 vcc, 1, v27
  s_cbranch_vccz L_ldone_33
  s_add_u32 s69, s69, 1
  s_cmp_lt_u32 s69, 4194304
  s_cbranch_scc1 L_lspin_32
  s_mov_b32 s12, s40
  s_mov_b32 s13, s41
  s_mov_b32 s14, 256
  s_mov_b32 s15, 0x20000
  v_mov_b32 v2, 80
  v_mov_b32 v3, s2
  v_or_b32 v3, 0x10000, v3
  buffer_store_dword v3, v2, s[12:15], 0 offen
  s_waitcnt vmcnt(0)
L_ldone_33:
  s_nop 1
  s_mov_b32 s69, 0
  buffer_load_dwordx4 v[32:35], v12, s[44:47], s94 offen sc1
  buffer_load_dwordx4 v[36:39], v12, s[44:47], s95 offen sc1
L_poll_34:
  buffer_load_dwordx4 v[40:43], v12, s[44:47], s94 offen sc1
  buffer_load_dwordx4 v[44:47], v12, s[44:47], s95 offen sc1
  s_waitcnt vmcnt(2)
  v_xor_b32 v32, s61, v32
  v_xor_b32 v33, s62, v33
  v_xor_b32 v34, s63, v34
  v_xor_b32 v35, s64, v35
  v_xor_b32 v36, s61, v36
  v_xor_b32 v37, s62, v37
  v_xor_b32 v38, s63, v38
  v_xor_b32 v39, s64, v39
  v_or_b32 v1, v32, v33
  v_or3_b32 v1, v1, v34, v35
  v_or3_b32 v1, v1, v36, v37
  v_or3_b32 v1, v1, v38, v39
  v_and_b32 v1, s8, v1
  v_cmp_ne_u32 vcc, 0, v1
  s_cbranch_vccz L_d0_35
  buffer_load_dwordx4 v[32:35], v12, s[44:47], s94 offen sc1
  buffer_load_dwordx4 v[36:39], v12, s[44:47], s95 offen sc1
  s_waitcnt vmcnt(2)
  v_xor_b32 v40, s61, v40
  v_xor_b32 v41, s62, v41
  v_xor_b32 v42, s63, v42
  v_xor_b32 v43, s64, v43
  v_xor_b32 v44, s61, v44
  v_xor_b32 v45, s62, v45
  v_xor_b32 v46, s63, v46
  v_xor_b32 v47, s64, v47
  v_or_b32 v1, v40, v41
  v_or3_b32 v1, v1, v42, v43
  v_or3_b32 v1, v1, v44, v45
  v_or3_b32 v1, v1, v46, v47
  v_and_b32 v1, s8, v1
  v_cmp_ne_u32 vcc, 0, v1
  s_cbranch_vccz L_d1_36
  s_add_u32 s69, s69, 1
  s_cmp_lt_u32 s69, 65536
  s_cbranch_scc1 L_poll_34
  s_mov_b32 s12, s40
  s_mov_b32 s13, s41
  s_mov_b32 s14, 256
  s_mov_b32 s15, 0x20000
  v_mov_b32 v2, 36
  v_mov_b32 v3, s2
  v_or_b32 v3, 0x10000, v3
  buffer_store_dword v3, v2, s[12:15], 0 offen
  s_waitcnt vmcnt(0)
L_d1_36:
  s_nop 1
  v_add_f32 v16, v40, v44
  v_add_f32 v17, v41, v45
  v_add_f32 v18, v42, v46
  v_add_f32 v19, v43, v47
  s_branch L_pend_37
L_d0_35:
  s_nop 1
  v_add_f32 v16, v32, v36
  v_add_f32 v17, v33, v37
  v_add_f32 v18, v34, v38
  v_add_f32 v19, v35, v39
L_pend_37:
  s_nop 1
  v_add_f32_dpp v16, v16, v16 row_ror:4 row_mask:0xf bank_mask:0xf
  v_add_f32_dpp v17, v17, v17 row_ror:4 row_mask:0xf bank_mask:0xf
  v_add_f32_dpp v18, v18, v18 row_ror:4 row_mask:0xf bank_mask:0xf
  v_add_f32_dpp v19, v19, v19 row_ror:4 row_mask:0xf bank_mask:0xf
  v_add_f32_dpp v16, v16, v16 row_ror:8 row_mask:0xf bank_mask:0xf
  v_add_f32_dpp v17, v17, v17 row_ror:8 row_mask:0xf bank_mask:0xf
  v_add_f32_dpp v18, v18, v18 row_ror:8 row_mask:0xf bank_mask:0xf
  v_add_f32_dpp v19, v19, v19 row_ror:8 row_mask:0xf bank_mask:0xf
  v_mov_b32 v20, v16
  v_mov_b32 v21, v17
  v_mov_b32 v22, v18
  v_mov_b32 v23, v19
  v_permlane16_swap_b32 v16, v20
  v_permlane16_swap_b32 v17, v21
  v_permlane16_swap_b32 v18, v22
  v_permlane16_swap_b32 v19, v23
  v_add_f32 v16, v16, v20
  v_add_f32 v17, v17, v21
  v_add_f32 v18, v18, v22
  v_add_f32 v19, v19, v23
  v_mov_b32 v20, v16
  v_mov_b32 v21, v17
  v_mov_b32 v22, v18
  v_mov_b32 v23, v19
  v_permlane32_swap_b32 v16, v20
  v_permlane32_swap_b32 v17, v21
  v_permlane32_swap_b32 v18, v22
  v_permlane32_swap_b32 v19, v23
  v_add_f32 v16, v16, v20
  v_add_f32 v17, v17, v21
  v_add_f32 v18, v18, v22
  v_add_f32 v19, v19, v23
  v_cvt_pk_bf16_f32 v16, v16, v17
  v_cvt_pk_bf16_f32 v17, v18, v19
  v_cmp_gt_u32 vcc, 4, v0
  s_nop 1
  s_and_saveexec_b64 s[14:15], vcc
  buffer_store_dwordx2 v[16:17], v13, s[56:59], s96 offen
  s_mov_b64 exec, s[14:15]
  s_cmp_lg_u32 s2, 128
  s_cbranch_scc1 L_noepoch_38
  v_mov_b32 v24, 141316
  s_cmp_lg_u32 s3, 0
  s_cbranch_scc1 L_w1_39
  s_mov_b32 s69, 0
L_lspin_40:
  ds_read_b32 v25, v24 offset:0
  s_waitcnt lgkmcnt(0)
  v_cmp_ne_u32 vcc, 1, v25
  s_cbranch_vccz L_ldone_41
  s_add_u32 s69, s69, 1
  s_cmp_lt_u32 s69, 4194304
  s_cbranch_scc1 L_lspin_40
  s_mov_b32 s12, s40
  s_mov_b32 s13, s41
  s_mov_b32 s14, 256
  s_mov_b32 s15, 0x20000
  v_mov_b32 v2, 52
  v_mov_b32 v3, s2
  v_or_b32 v3, 0x10000, v3
  buffer_store_dword v3, v2, s[12:15], 0 offen
  s_waitcnt vmcnt(0)
L_ldone_41:
  s_nop 1
  v_mov_b32 v25, s60
  v_mov_b32 v26, 0
  s_mov_b64 exec, 1
  buffer_store_dword v25, v26, s[44:47], 0 offen
  s_mov_b64 exec, -1
  s_branch L_noepoch_38
L_w1_39:
  s_nop 1
  v_mov_b32 v25, 1
  ds_write_b32 v24, v25
  s_waitcnt lgkmcnt(0)
L_noepoch_38:
  s_nop 1
L_nofinal_31:
  s_nop 1
  s_endpgm
L_attb:
  s_nop 1
  s_waitcnt lgkmcnt(0)
  s_add_u32 s44, s42, 0
  s_addc_u32 s45, s43, 0
  s_mov_b32 s46, 7864320
  s_mov_b32 s47, 0x20000
  s_load_dword s60, s[44:45], 0
  s_mov_b32 s48, s30
  s_mov_b32 s49, s31
  s_mov_b32 s50, 33554432
  s_mov_b32 s51, 0x20000
  s_mov_b32 s52, s32
  s_mov_b32 s53, s33
  s_mov_b32 s54, 33554432
  s_mov_b32 s55, 0x20000
  v_and_b32 v4, 15, v0
  v_lshrrev_b32 v5, 4, v0
  v_lshlrev_b32 v6, 4, v0
  s_lshr_b32 s92, s5, 2
  s_and_b32 s93, s5, 3
  s_lshl_b32 s94, s92, 3
  s_add_u32 s94, s94, s4
  s_lshl_b32 s94, s94, 12
  s_add_u32 s94, s94, 3072
  s_lshl_b32 s12, s93, 8
  s_add_u32 s94, s94, s12
  s_lshl_b32 s12, s3, 6
  s_add_u32 s94, s94, s12
  s_lshl_b32 s94, s94, 8
  s_lshl_b32 s95, s3, 15
  v_mov_b32 v60, 133120
  v_mov_b32 v62, 0
  v_mov_b32 v63, 0
  ds_write_b64 v60, v[62:63]
  ds_write_b64 v60, v[62:63] offset:8
  ds_write_b64 v60, v[62:63] offset:16
  v_xor_b32 v8, v4, v5
  v_lshlrev_b32 v8, 4, v8
  v_lshl_add_u32 v8, v5, 8, v8
  v_lshlrev_b32 v9, 1, v5
  v_xor_b32 v9, v4, v9
  v_lshlrev_b32 v9, 4, v9
  v_lshl_add_u32 v9, v5, 8, v9
  v_xor_b32 v40, v4, v5
  v_lshlrev_b32 v40, 4, v40
  v_lshl_add_u32 v40, v4, 8, v40
  v_add_u32 v40, s95, v40
  v_xor_b32 v41, 64, v40
  v_xor_b32 v42, 128, v40
  v_xor_b32 v43, 192, v40
  v_lshrrev_b32 v44, 2, v4
  v_and_b32 v45, 3, v4
  v_and_b32 v46, 1, v5
  v_lshlrev_b32 v46, 3, v46
  v_lshl_add_u32 v46, v44, 1, v46
  v_lshrrev_b32 v47, 1, v5
  v_add_u32 v46, v46, v47
  v_lshrrev_b32 v47, 1, v45
  v_xor_b32 v46, v46, v47
  v_lshlrev_b32 v46, 4, v46
  v_and_b32 v47, 1, v45
  v_lshl_add_u32 v46, v47, 3, v46
  v_lshl_add_u32 v47, v5, 2, v44
  v_lshl_add_u32 v46, v47, 8, v46
  v_add_u32 v48, s95, v46
  v_add_u32 v48, 16384, v48
  v_xor_b32 v49, 32, v48
  v_xor_b32 v50, 64, v48
  v_xor_b32 v51, 96, v48
  v_xor_b32 v52, 128, v48
  v_xor_b32 v53, 160, v48
  v_xor_b32 v54, 192, v48
  v_xor_b32 v55, 224, v48
  v_and_b32 v11, 3, v4
  v_lshlrev_b32 v11, 8, v11
  v_lshl_add_u32 v11, v5, 4, v11
  v_add_u32 v11, 131072, v11
  s_waitcnt lgkmcnt(0)
  s_add_u32 s60, s60, 1
  s_and_b32 s61, s60, 0xff
  s_xor_b32 s62, s61, 0xa5
  s_lshr_b32 s63, s60, 8
  s_and_b32 s63, s63, 0xff
  s_xor_b32 s63, s63, 0x96
  s_lshr_b32 s64, s60, 16
  s_and_b32 s64, s64, 0xff
  s_xor_b32 s64, s64, s61
  s_xor_b32 s64, s64, 0x3c
  s_lshr_b32 s12, s61, 0
  s_and_b32 s12, s12, 1
  s_lshr_b32 s13, s61, 1
  s_and_b32 s13, s13, 1
  s_lshl_b32 s13, s13, 16
  s_or_b32 s65, s12, s13
  s_lshr_b32 s12, s61, 2
  s_and_b32 s12, s12, 1
  s_lshr_b32 s13, s61, 3
  s_and_b32 s13, s13, 1
  s_lshl_b32 s13, s13, 16
  s_or_b32 s66, s12, s13
  s_lshr_b32 s12, s61, 4
  s_and_b32 s12, s12, 1
  s_lshr_b32 s13, s61, 5
  s_and_b32 s13, s13, 1
  s_lshl_b32 s13, s13, 16
  s_or_b32 s67, s12, s13
  s_lshr_b32 s12, s61, 6
  s_and_b32 s12, s12, 1
  s_lshr_b32 s13, s61, 7
  s_and_b32 s13, s13, 1
  s_lshl_b32 s13, s13, 16
  s_or_b32 s68, s12, s13
  s_barrier
  s_barrier
  s_mov_b32 s69, 0
L_lspin_42:
  ds_read_b32 v61, v60 offset:4
  s_waitcnt lgkmcnt(0)
  v_cmp_ne_u32 vcc, 1, v61
  s_cbranch_vccz L_ldone_43
  s_add_u32 s69, s69, 1
  s_cmp_lt_u32 s69, 4194304
  s_cbranch_scc1 L_lspin_42
  s_mov_b32 s12, s40
  s_mov_b32 s13, s41
  s_mov_b32 s14, 256
  s_mov_b32 s15, 0x20000
  v_mov_b32 v2, 56
  v_mov_b32 v3, s2
  v_or_b32 v3, 0x10000, v3
  buffer_store_dword v3, v2, s[12:15], 0 offen
  s_waitcnt vmcnt(0)
L_ldone_43:
  s_nop 1
  s_lshl_b32 s96, s4, 4
  s_add_u32 s96, s96, s5
  s_lshl_b32 s96, s96, 7
  s_add_u32 s96, s96, 7151616
  v_mov_b32 v12, 0
  s_mov_b32 s69, 0
L_spoll_44:
  s_load_dwordx4 s[88:91], s[44:45], s96 glc
  s_waitcnt lgkmcnt(0)
  s_xor_b32 s88, s88, s61
  s_xor_b32 s89, s89, s62
  s_xor_b32 s90, s90, s63
  s_xor_b32 s91, s91, s64
  s_or_b32 s88, s88, s89
  s_or_b32 s90, s90, s91
  s_or_b32 s88, s88, s90
  s_cmp_eq_u32 s88, 0
  s_cbranch_scc1 L_sdone_45
  s_sleep 2
  s_add_u32 s69, s69, 1
  s_cmp_lt_u32 s69, 32
  s_cbranch_scc1 L_spoll_44
L_sdone_45:
  s_nop 1
  s_add_u32 m0, s95, 0
  s_add_u32 s12, s94, 0
  buffer_load_dwordx4 v8, s[48:51], s12 offen nt lds
  s_add_u32 m0, s95, 1024
  v_xor_b32 v10, 64, v8
  s_add_u32 s12, s94, 1024
  buffer_load_dwordx4 v10, s[48:51], s12 offen nt lds
  s_add_u32 m0, s95, 2048
  v_xor_b32 v10, 128, v8
  s_add_u32 s12, s94, 2048
  buffer_load_dwordx4 v10, s[48:51], s12 offen nt lds
  s_add_u32 m0, s95, 3072
  v_xor_b32 v10, 192, v8
  s_add_u32 s12, s94, 3072
  buffer_load_dwordx4 v10, s[48:51], s12 offen nt lds
  s_add_u32 m0, s95, 4096
  s_add_u32 s12, s94, 4096
  buffer_load_dwordx4 v8, s[48:51], s12 offen nt lds
  s_add_u32 m0, s95, 5120
  v_xor_b32 v10, 64, v8
  s_add_u32 s12, s94, 5120
  buffer_load_dwordx4 v10, s[48:51], s12 offen nt lds
  s_add_u32 m0, s95, 6144
  v_xor_b32 v10, 128, v8
  s_add_u32 s12, s94, 6144
  buffer_load_dwordx4 v10, s[48:51], s12 offen nt lds
  s_add_u32 m0, s95, 7168
  v_xor_b32 v10, 192, v8
  s_add_u32 s12, s94, 7168
  buffer_load_dwordx4 v10, s[48:51], s12 offen nt lds
  s_waitcnt vmcnt(7)
  s_add_u32 m0, s95, 8192
  s_add_u32 s12, s94, 8192
  buffer_load_dwordx4 v8, s[48:51], s12 offen nt lds
  s_waitcnt vmcnt(7)
  s_add_u32 m0, s95, 9216
  v_xor_b32 v10, 64, v8
  s_add_u32 s12, s94, 9216
  buffer_load_dwordx4 v10, s[48:51], s12 offen nt lds
  s_waitcnt vmcnt(7)
  s_add_u32 m0, s95, 10240
  v_xor_b32 v10, 128, v8
  s_add_u32 s12, s94, 10240
  buffer_load_dwordx4 v10, s[48:51], s12 offen nt lds
  s_waitcnt vmcnt(7)
  s_add_u32 m0, s95, 11264
  v_xor_b32 v10, 192, v8
  s_add_u32 s12, s94, 11264
  buffer_load_dwordx4 v10, s[48:51], s12 offen nt lds
  s_waitcnt vmcnt(7)
  s_add_u32 m0, s95, 12288
  s_add_u32 s12, s94, 12288
  buffer_load_dwordx4 v8, s[48:51], s12 offen nt lds
  s_waitcnt vmcnt(7)
  s_add_u32 m0, s95, 13312
  v_xor_b32 v10, 64, v8
  s_add_u32 s12, s94, 13312
  buffer_load_dwordx4 v10, s[48:51], s12 offen nt lds
  s_waitcnt vmcnt(7)
  s_add_u32 m0, s95, 14336
  v_xor_b32 v10, 128, v8
  s_add_u32 s12, s94, 14336
  buffer_load_dwordx4 v10, s[48:51], s12 offen nt lds
  s_waitcnt vmcnt(7)
  s_add_u32 m0, s95, 15360
  v_xor_b32 v10, 192, v8
  s_add_u32 s12, s94, 15360
  buffer_load_dwordx4 v10, s[48:51], s12 offen nt lds
  s_waitcnt vmcnt(7)
  s_add_u32 m0, s95, 16384
  s_add_u32 s12, s94, 0
  buffer_load_dwordx4 v9, s[52:55], s12 offen nt lds
  s_waitcnt vmcnt(7)
  s_add_u32 m0, s95, 17408
  v_xor_b32 v10, 128, v9
  s_add_u32 s12, s94, 1024
  buffer_load_dwordx4 v10, s[52:55], s12 offen nt lds
  s_waitcnt vmcnt(7)
  s_add_u32 m0, s95, 18432
  v_xor_b32 v10, 16, v9
  s_add_u32 s12, s94, 2048
  buffer_load_dwordx4 v10, s[52:55], s12 offen nt lds
  s_waitcnt vmcnt(7)
  s_add_u32 m0, s95, 19456
  v_xor_b32 v10, 144, v9
  s_add_u32 s12, s94, 3072
  buffer_load_dwordx4 v10, s[52:55], s12 offen nt lds
  s_waitcnt vmcnt(7)
  s_add_u32 m0, s95, 20480
  s_add_u32 s12, s94, 4096
  buffer_load_dwordx4 v9, s[52:55], s12 offen nt lds
  s_waitcnt vmcnt(7)
  s_add_u32 m0, s95, 21504
  v_xor_b32 v10, 128, v9
  s_add_u32 s12, s94, 5120
  buffer_load_dwordx4 v10, s[52:55], s12 offen nt lds
  s_waitcnt vmcnt(7)
  s_add_u32 m0, s95, 22528
  v_xor_b32 v10, 16, v9
  s_add_u32 s12, s94, 6144
  buffer_load_dwordx4 v10, s[52:55], s12 offen nt lds
  s_waitcnt vmcnt(7)
  s_add_u32 m0, s95, 23552
  v_xor_b32 v10, 144, v9
  s_add_u32 s12, s94, 7168
  buffer_load_dwordx4 v10, s[52:55], s12 offen nt lds
  s_waitcnt vmcnt(7)
  s_add_u32 m0, s95, 24576
  s_add_u32 s12, s94, 8192
  buffer_load_dwordx4 v9, s[52:55], s12 offen nt lds
  s_waitcnt vmcnt(7)
  s_add_u32 m0, s95, 25600
  v_xor_b32 v10, 128, v9
  s_add_u32 s12, s94, 9216
  buffer_load_dwordx4 v10, s[52:55], s12 offen nt lds
  s_waitcnt vmcnt(7)
  s_add_u32 m0, s95, 26624
  v_xor_b32 v10, 16, v9
  s_add_u32 s12, s94, 10240
  buffer_load_dwordx4 v10, s[52:55], s12 offen nt lds
  s_waitcnt vmcnt(7)
  s_add_u32 m0, s95, 27648
  v_xor_b32 v10, 144, v9
  s_add_u32 s12, s94, 11264
  buffer_load_dwordx4 v10, s[52:55], s12 offen nt lds
  s_waitcnt vmcnt(7)
  s_add_u32 m0, s95, 28672
  s_add_u32 s12, s94, 12288
  buffer_load_dwordx4 v9, s[52:55], s12 offen nt lds
  s_waitcnt vmcnt(7)
  s_add_u32 m0, s95, 29696
  v_xor_b32 v10, 128, v9
  s_add_u32 s12, s94, 13312
  buffer_load_dwordx4 v10, s[52:55], s12 offen nt lds
  s_waitcnt vmcnt(7)
  s_add_u32 m0, s95, 30720
  v_xor_b32 v10, 16, v9
  s_add_u32 s12, s94, 14336
  buffer_load_dwordx4 v10, s[52:55], s12 offen nt lds
  s_waitcnt vmcnt(7)
  s_add_u32 m0, s95, 31744
  v_xor_b32 v10, 144, v9
  s_add_u32 s12, s94, 15360
  buffer_load_dwordx4 v10, s[52:55], s12 offen nt lds
  s_mov_b64 exec, 1
  v_mov_b32 v61, 1
  ds_add_u32 v60, v61 offset:8
  s_mov_b64 exec, -1
  s_waitcnt vmcnt(16)
  s_mov_b32 s69, 0
L_lspin_46:
  ds_read_b32 v61, v60 offset:0
  s_waitcnt lgkmcnt(0)
  v_cmp_ne_u32 vcc, 1, v61
  s_cbranch_vccz L_ldone_47
  s_add_u32 s69, s69, 1
  s_cmp_lt_u32 s69, 4194304
  s_cbranch_scc1 L_lspin_46
  s_mov_b32 s12, s40
  s_mov_b32 s13, s41
  s_mov_b32 s14, 256
  s_mov_b32 s15, 0x20000
  v_mov_b32 v2, 44
  v_mov_b32 v3, s2
  v_or_b32 v3, 0x10000, v3
  buffer_store_dword v3, v2, s[12:15], 0 offen
  s_waitcnt vmcnt(0)
L_ldone_47:
  s_nop 1
  ds_read_b128 v[16:19], v11 offset:0
  ds_read_b128 v[20:23], v11 offset:64
  ds_read_b128 v[24:27], v11 offset:128
  ds_read_b128 v[28:31], v11 offset:192
  ds_read_b128 v[64:67], v40 offset:0
  ds_read_b128 v[68:71], v41 offset:0
  ds_read_b128 v[72:75], v42 offset:0
  ds_read_b128 v[76:79], v43 offset:0
  ds_read_b128 v[80:83], v40 offset:4096
  ds_read_b128 v[84:87], v41 offset:4096
  ds_read_b128 v[88:91], v42 offset:4096
  ds_read_b128 v[92:95], v43 offset:4096
  ds_read_b128 v[96:99], v40 offset:8192
  ds_read_b128 v[100:103], v41 offset:8192
  ds_read_b128 v[104:107], v42 offset:8192
  ds_read_b128 v[108:111], v43 offset:8192
  ds_read_b128 v[112:115], v40 offset:12288
  ds_read_b128 v[116:119], v41 offset:12288
  ds_read_b128 v[120:123], v42 offset:12288
  ds_read_b128 v[124:127], v43 offset:12288
  s_waitcnt lgkmcnt(12)
  v_mfma_f32_16x16x32_bf16 v[128:131], v[64:67], v[16:19], 0
  v_mfma_f32_16x16x32_bf16 v[128:131], v[68:71], v[20:23], v[128:131]
  v_mfma_f32_16x16x32_bf16 v[128:131], v[72:75], v[24:27], v[128:131]
  v_mfma_f32_16x16x32_bf16 v[128:131], v[76:79], v[28:31], v[128:131]
  s_waitcnt lgkmcnt(8)
  v_mfma_f32_16x16x32_bf16 v[132:135], v[80:83], v[16:19], 0
  v_mfma_f32_16x16x32_bf16 v[132:135], v[84:87], v[20:23], v[132:135]
  v_mfma_f32_16x16x32_bf16 v[132:135], v[88:91], v[24:27], v[132:135]
  v_mfma_f32_16x16x32_bf16 v[132:135], v[92:95], v[28:31], v[132:135]
  s_waitcnt lgkmcnt(4)
  v_mfma_f32_16x16x32_bf16 v[136:139], v[96:99], v[16:19], 0
  v_mfma_f32_16x16x32_bf16 v[136:139], v[100:103], v[20:23], v[136:139]
  v_mfma_f32_16x16x32_bf16 v[136:139], v[104:107], v[24:27], v[136:139]
  v_mfma_f32_16x16x32_bf16 v[136:139], v[108:111], v[28:31], v[136:139]
  s_waitcnt lgkmcnt(0)
  v_mfma_f32_16x16x32_bf16 v[140:143], v[112:115], v[16:19], 0
  v_mfma_f32_16x16x32_bf16 v[140:143], v[116:119], v[20:23], v[140:143]
  v_mfma_f32_16x16x32_bf16 v[140:143], v[120:123], v[24:27], v[140:143]
  v_mfma_f32_16x16x32_bf16 v[140:143], v[124:127], v[28:31], v[140:143]
  v_max3_f32 v56, v128, v129, v130
  v_max3_f32 v56, v56, v131, v132
  v_max3_f32 v56, v56, v133, v134
  v_max3_f32 v56, v56, v135, v136
  v_max3_f32 v56, v56, v137, v138
  s_nop 2
  v_max3_f32 v56, v56, v139, v140
  v_max3_f32 v56, v56, v141, v142
  v_max_f32 v56, v56, v143
  v_mov_b32 v57, v56
  s_nop 1
  v_permlane16_swap_b32 v56, v57
  v_max_f32 v56, v56, v57
  v_mov_b32 v57, v56
  s_nop 1
  v_permlane32_swap_b32 v56, v57
  v_max_f32 v56, v56, v57
  s_mov_b32 s12, 0x3e0293ee
  v_mul_f32 v56, s12, v56
  v_fma_f32 v128, v128, s12, -v56
  v_fma_f32 v129, v129, s12, -v56
  v_fma_f32 v130, v130, s12, -v56
  v_fma_f32 v131, v131, s12, -v56
  v_fma_f32 v132, v132, s12, -v56
  v_fma_f32 v133, v133, s12, -v56
  v_fma_f32 v134, v134, s12, -v56
  v_fma_f32 v135, v135, s12, -v56
  v_fma_f32 v136, v136, s12, -v56
  v_fma_f32 v137, v137, s12, -v56
  v_fma_f32 v138, v138, s12, -v56
  v_fma_f32 v139, v139, s12, -v56
  v_fma_f32 v140, v140, s12, -v56
  v_fma_f32 v141, v141, s12, -v56
  v_fma_f32 v142, v142, s12, -v56
  v_fma_f32 v143, v143, s12, -v56
  v_exp_f32 v128, v128
  v_exp_f32 v129, v129
  v_exp_f32 v130, v130
  v_exp_f32 v131, v131
  v_exp_f32 v132, v132
  v_exp_f32 v133, v133
  v_exp_f32 v134, v134
  v_exp_f32 v135, v135
  v_exp_f32 v136, v136
  v_exp_f32 v137, v137
  v_exp_f32 v138, v138
  v_exp_f32 v139, v139
  v_exp_f32 v140, v140
  v_exp_f32 v141, v141
  v_exp_f32 v142, v142
  v_exp_f32 v143, v143
  v_add_f32 v58, v128, v129
  v_add_f32 v58, v58, v130
  v_add_f32 v58, v58, v131
  v_add_f32 v58, v58, v132
  v_add_f32 v58, v58, v133
  v_add_f32 v58, v58, v134
  v_add_f32 v58, v58, v135
  v_add_f32 v58, v58, v136
  v_add_f32 v58, v58, v137
  v_add_f32 v58, v58, v138
  v_add_f32 v58, v58, v139
  v_add_f32 v58, v58, v140
  v_add_f32 v58, v58, v141
  v_add_f32 v58, v58, v142
  v_add_f32 v58, v58, v143
  v_mov_b32 v57, v58
  s_nop 1
  v_permlane16_swap_b32 v58, v57
  v_add_f32 v58, v58, v57
  v_mov_b32 v57, v58
  s_nop 1
  v_permlane32_swap_b32 v58, v57
  v_add_f32 v58, v58, v57
  v_cvt_pk_bf16_f32 v144, v128, v129
  v_cvt_pk_bf16_f32 v145, v130, v131
  v_cvt_pk_bf16_f32 v146, v132, v133
  v_cvt_pk_bf16_f32 v147, v134, v135
  v_cvt_pk_bf16_f32 v148, v136, v137
  v_cvt_pk_bf16_f32 v149, v138, v139
  v_cvt_pk_bf16_f32 v150, v140, v141
  v_cvt_pk_bf16_f32 v151, v142, v143
  s_waitcnt vmcnt(0)
  ds_read_b64_tr_b16 v[64:65], v48 offset:0
  ds_read_b64_tr_b16 v[66:67], v48 offset:4096
  ds_read_b64_tr_b16 v[68:69], v48 offset:8192
  ds_read_b64_tr_b16 v[70:71], v48 offset:12288
  ds_read_b64_tr_b16 v[72:73], v49 offset:0
  ds_read_b64_tr_b16 v[74:75], v49 offset:4096
  ds_read_b64_tr_b16 v[76:77], v49 offset:8192
  ds_read_b64_tr_b16 v[78:79], v49 offset:12288
  ds_read_b64_tr_b16 v[80:81], v50 offset:0
  ds_read_b64_tr_b16 v[82:83], v50 offset:4096
  ds_read_b64_tr_b16 v[84:85], v50 offset:8192
  ds_read_b64_tr_b16 v[86:87], v50 offset:12288
  ds_read_b64_tr_b16 v[88:89], v51 offset:0
  ds_read_b64_tr_b16 v[90:91], v51 offset:4096
  ds_read_b64_tr_b16 v[92:93], v51 offset:8192
  ds_read_b64_tr_b16 v[94:95], v51 offset:12288
  ds_read_b64_tr_b16 v[96:97], v52 offset:0
  ds_read_b64_tr_b16 v[98:99], v52 offset:4096
  ds_read_b64_tr_b16 v[100:101], v52 offset:8192
  ds_read_b64_tr_b16 v[102:103], v52 offset:12288
  ds_read_b64_tr_b16 v[104:105], v53 offset:0
  ds_read_b64_tr_b16 v[106:107], v53 offset:4096
  ds_read_b64_tr_b16 v[108:109], v53 offset:8192
  ds_read_b64_tr_b16 v[110:111], v53 offset:12288
  ds_read_b64_tr_b16 v[112:113], v54 offset:0
  ds_read_b64_tr_b16 v[114:115], v54 offset:4096
  ds_read_b64_tr_b16 v[116:117], v54 offset:8192
  ds_read_b64_tr_b16 v[118:119], v54 offset:12288
  ds_read_b64_tr_b16 v[120:121], v55 offset:0
  ds_read_b64_tr_b16 v[122:123], v55 offset:4096
  ds_read_b64_tr_b16 v[124:125], v55 offset:8192
  ds_read_b64_tr_b16 v[126:127], v55 offset:12288
  s_waitcnt lgkmcnt(15)
  v_mfma_f32_16x16x32_bf16 v[160:163], v[64:67], v[144:147], 0
  v_mfma_f32_16x16x32_bf16 v[160:163], v[68:71], v[148:151], v[160:163]
  s_waitcnt lgkmcnt(15)
  v_mfma_f32_16x16x32_bf16 v[164:167], v[72:75], v[144:147], 0
  v_mfma_f32_16x16x32_bf16 v[164:167], v[76:79], v[148:151], v[164:167]
  s_waitcnt lgkmcnt(15)
  v_mfma_f32_16x16x32_bf16 v[168:171], v[80:83], v[144:147], 0
  v_mfma_f32_16x16x32_bf16 v[168:171], v[84:87], v[148:151], v[168:171]
  s_waitcnt lgkmcnt(15)
  v_mfma_f32_16x16x32_bf16 v[172:175], v[88:91], v[144:147], 0
  v_mfma_f32_16x16x32_bf16 v[172:175], v[92:95], v[148:151], v[172:175]
  s_waitcnt lgkmcnt(12)
  v_mfma_f32_16x16x32_bf16 v[176:179], v[96:99], v[144:147], 0
  v_mfma_f32_16x16x32_bf16 v[176:179], v[100:103], v[148:151], v[176:179]
  s_waitcnt lgkmcnt(8)
  v_mfma_f32_16x16x32_bf16 v[180:183], v[104:107], v[144:147], 0
  v_mfma_f32_16x16x32_bf16 v[180:183], v[108:111], v[148:151], v[180:183]
  s_waitcnt lgkmcnt(4)
  v_mfma_f32_16x16x32_bf16 v[184:187], v[112:115], v[144:147], 0
  v_mfma_f32_16x16x32_bf16 v[184:187], v[116:119], v[148:151], v[184:187]
  s_waitcnt lgkmcnt(0)
  v_mfma_f32_16x16x32_bf16 v[188:191], v[120:123], v[144:147], 0
  v_mfma_f32_16x16x32_bf16 v[188:191], v[124:127], v[148:151], v[188:191]
  s_lshl_b32 s12, s3, 11
  s_add_u32 s12, s12, 135168
  v_lshlrev_b32 v12, 9, v4
  v_lshl_add_u32 v12, v5, 4, v12
  v_add_u32 v12, s12, v12
  s_lshl_b32 s13, s3, 2
  s_add_u32 s13, s13, 143360
  v_lshlrev_b32 v13, 4, v4
  v_add_u32 v13, s13, v13
  v_cmp_gt_u32 vcc, 4, v4
  s_nop 1
  s_and_saveexec_b64 s[14:15], vcc
  ds_write_b128 v12, v[160:163] offset:0
  ds_write_b128 v12, v[164:167] offset:64
  ds_write_b128 v12, v[168:171] offset:128
  ds_write_b128 v12, v[172:175] offset:192
  ds_write_b128 v12, v[176:179] offset:256
  ds_write_b128 v12, v[180:183] offset:320
  ds_write_b128 v12, v[184:187] offset:384
  ds_write_b128 v12, v[188:191] offset:448
  ds_write_b32 v13, v56
  ds_write_b32 v13, v58 offset:64
  s_mov_b64 exec, s[14:15]
  s_lshl_b32 s96, s92, 3
  s_add_u32 s96, s96, s4
  s_lshl_b32 s96, s96, 2
  s_add_u32 s96, s96, s93
  s_lshl_b32 s96, s96, 2
  s_add_u32 s96, s96, s3
  s_lshl_b32 s96, s96, 10
  s_add_u32 s96, s96, 987136
  s_lshl_b32 s12, s3, 9
  s_add_u32 s12, s12, 135168
  v_and_b32 v12, 31, v0
  v_lshlrev_b32 v12, 4, v12
  v_add_u32 v12, s12, v12
  s_lshl_b32 s13, s3, 4
  s_add_u32 s13, s13, 143360
  v_mov_b32 v13, s13
  v_mov_b32 v40, s61
  v_mov_b32 v41, s62
  v_mov_b32 v42, s63
  v_mov_b32 v43, s64
  v_mov_b32 v2, 133136
  ds_read_b32 v2, v2
  s_waitcnt lgkmcnt(0)
  v_readfirstlane_b32 s97, v2
  s_mov_b64 exec, 1
  v_mov_b32 v61, 1
  ds_add_u32 v60, v61 offset:12
  s_mov_b64 exec, -1
  s_mov_b32 s69, 0
L_lspin_48:
  ds_read_b32 v61, v60 offset:12
  s_waitcnt lgkmcnt(0)
  v_cmp_ne_u32 vcc, 4, v61
  s_cbranch_vccz L_ldone_49
  s_add_u32 s69, s69, 1
  s_cmp_lt_u32 s69, 4194304
  s_cbranch_scc1 L_lspin_48
  s_mov_b32 s12, s40
  s_mov_b32 s13, s41
  s_mov_b32 s14, 256
  s_mov_b32 s15, 0x20000
  v_mov_b32 v2, 60
  v_mov_b32 v3, s2
  v_or_b32 v3, 0x10000, v3
  buffer_store_dword v3, v2, s[12:15], 0 offen
  s_waitcnt vmcnt(0)
L_ldone_49:
  s_nop 1
  ds_read_b128 v[64:67], v12 offset:0
  ds_read_b128 v[68:71], v12 offset:2048
  ds_read_b128 v[72:75], v12 offset:4096
  ds_read_b128 v[76:79], v12 offset:6144
  ds_read_b128 v[80:83], v13
  ds_read_b128 v[84:87], v13 offset:64
  s_waitcnt lgkmcnt(0)
  v_max3_f32 v88, v80, v81, v82
  v_max_f32 v88, v88, v83
  v_sub_f32 v80, v80, v88
  v_sub_f32 v81, v81, v88
  v_sub_f32 v82, v82, v88
  v_sub_f32 v83, v83, v88
  v_exp_f32 v80, v80
  v_exp_f32 v81, v81
  v_exp_f32 v82, v82
  v_exp_f32 v83, v83
  v_mul_f32 v89, v80, v84
  v_fmac_f32 v89, v81, v85
  v_fmac_f32 v89, v82, v86
  v_fmac_f32 v89, v83, v87
  v_mul_f32 v92, v80, v64
  v_fmac_f32 v92, v81, v68
  v_fmac_f32 v92, v82, v72
  v_fmac_f32 v92, v83, v76
  v_mul_f32 v93, v80, v65
  v_fmac_f32 v93, v81, v69
  v_fmac_f32 v93, v82, v73
  v_fmac_f32 v93, v83, v77
  v_mul_f32 v94, v80, v66
  v_fmac_f32 v94, v81, v70
  v_fmac_f32 v94, v82, v74
  v_fmac_f32 v94, v83, v78
  v_mul_f32 v95, v80, v67
  v_fmac_f32 v95, v81, v71
  v_fmac_f32 v95, v82, v75
  v_fmac_f32 v95, v83, v79
  v_cmp_lt_u32 vcc, 31, v0
  s_nop 1
  v_cndmask_b32 v92, v92, v88, vcc
  v_cndmask_b32 v93, v93, v89, vcc
  v_bfi_b32 v92, s8, v40, v92
  v_bfi_b32 v93, s8, v41, v93
  v_bfi_b32 v94, s8, v42, v94
  v_bfi_b32 v95, s8, v43, v95
  v_cmp_gt_u32 vcc, 40, v0
  s_nop 1
  s_and_saveexec_b64 s[14:15], vcc
  s_cmp_eq_u32 s97, 1
  s_cbranch_scc0 L_slow_50
  buffer_store_dwordx4 v[92:95], v6, s[44:47], s96 offen
  s_branch L_stend_51
L_slow_50:
  buffer_store_dwordx4 v[92:95], v6, s[44:47], s96 offen sc1
L_stend_51:
  s_mov_b64 exec, s[14:15]
  s_endpgm
L_g1:
  s_nop 1
  s_waitcnt lgkmcnt(0)
  s_add_u32 s44, s42, 0
  s_addc_u32 s45, s43, 0
  s_mov_b32 s46, 7864320
  s_mov_b32 s47, 0x20000
  s_load_dword s60, s[44:45], 0
  v_and_b32 v4, 15, v0
  v_lshrrev_b32 v5, 4, v0
  v_lshlrev_b32 v6, 4, v0
  s_mov_b32 s48, s34
  s_mov_b32 s49, s35
  s_mov_b32 s50, 4194304
  s_mov_b32 s51, 0x20000
  s_mov_b32 s52, s28
  s_mov_b32 s53, s29
  s_mov_b32 s54, 4096
  s_mov_b32 s55, 0x20000
  v_lshlrev_b32 v7, 16, v5
  v_lshl_add_u32 v7, v4, 4, v7
  v_lshrrev_b32 v8, 2, v4
  v_lshlrev_b32 v8, 10, v8
  v_lshl_add_u32 v8, v5, 4, v8
  s_lshl_b32 s12, s7, 8
  buffer_load_dwordx4 v[16:19], v8, s[52:55], s12 offen offset:0
  buffer_load_dwordx4 v[20:23], v8, s[52:55], s12 offen offset:64
  buffer_load_dwordx4 v[24:27], v8, s[52:55], s12 offen offset:128
  buffer_load_dwordx4 v[28:31], v8, s[52:55], s12 offen offset:192
  s_lshl_b32 s92, s7, 20
  s_lshl_b32 s14, s6, 8
  s_add_u32 s92, s92, s14
  v_lshlrev_b32 v11, 13, v5
  v_lshl_add_u32 v11, v4, 4, v11
  s_lshr_b32 s12, s5, 2
  s_lshl_b32 s12, s12, 8
  s_lshl_b32 s94, s4, 15
  s_add_u32 s94, s94, s12
  s_add_u32 s94, s94, 266240
  s_add_u32 s95, s94, 4096
  s_waitcnt lgkmcnt(0)
  s_add_u32 s60, s60, 1
  s_and_b32 s61, s60, 0xff
  s_xor_b32 s62, s61, 0xa5
  s_lshr_b32 s63, s60, 8
  s_and_b32 s63, s63, 0xff
  s_xor_b32 s63, s63, 0x96
  s_lshr_b32 s64, s60, 16
  s_and_b32 s64, s64, 0xff
  s_xor_b32 s64, s64, s61
  s_xor_b32 s64, s64, 0x3c
  s_lshr_b32 s12, s61, 0
  s_and_b32 s12, s12, 1
  s_lshr_b32 s13, s61, 1
  s_and_b32 s13, s13, 1
  s_lshl_b32 s13, s13, 16
  s_or_b32 s65, s12, s13
  s_lshr_b32 s12, s61, 2
  s_and_b32 s12, s12, 1
  s_lshr_b32 s13, s61, 3
  s_and_b32 s13, s13, 1
  s_lshl_b32 s13, s13, 16
  s_or_b32 s66, s12, s13
  s_lshr_b32 s12, s61, 4
  s_and_b32 s12, s12, 1
  s_lshr_b32 s13, s61, 5
  s_and_b32 s13, s13, 1
  s_lshl_b32 s13, s13, 16
  s_or_b32 s67, s12, s13
  s_lshr_b32 s12, s61, 6
  s_and_b32 s12, s12, 1
  s_lshr_b32 s13, s61, 7
  s_and_b32 s13, s13, 1
  s_lshl_b32 s13, s13, 16
  s_or_b32 s68, s12, s13
  v_mov_b32 v60, 133120
  s_barrier
  s_barrier
  buffer_load_dword v3, v11, s[44:47], s94 offen offset:0
  buffer_load_dword v3, v11, s[44:47], s94 offen offset:1024
  buffer_load_dword v3, v11, s[44:47], s94 offen offset:2048
  buffer_load_dword v3, v11, s[44:47], s94 offen offset:3072
  buffer_load_dword v3, v11, s[44:47], s95 offen offset:0
  buffer_load_dword v3, v11, s[44:47], s95 offen offset:1024
  buffer_load_dword v3, v11, s[44:47], s95 offen offset:2048
  buffer_load_dword v3, v11, s[44:47], s95 offen offset:3072
  buffer_load_dwordx4 v[64:67], v7, s[48:51], s92 offen nt
  s_add_u32 s92, s92, 8192
  buffer_load_dwordx4 v[68:71], v7, s[48:51], s92 offen nt
  s_add_u32 s92, s92, 8192
  buffer_load_dwordx4 v[72:75], v7, s[48:51], s92 offen nt
  s_add_u32 s92, s92, 8192
  buffer_load_dwordx4 v[76:79], v7, s[48:51], s92 offen nt
  s_add_u32 s92, s92, 8192
  buffer_load_dwordx4 v[80:83], v7, s[48:51], s92 offen nt
  s_add_u32 s92, s92, 8192
  buffer_load_dwordx4 v[84:87], v7, s[48:51], s92 offen nt
  s_add_u32 s92, s92, 8192
  buffer_load_dwordx4 v[88:91], v7, s[48:51], s92 offen nt
  s_add_u32 s92, s92, 8192
  buffer_load_dwordx4 v[92:95], v7, s[48:51], s92 offen nt
  s_add_u32 s92, s92, 204800
  buffer_load_dwordx4 v[96:99], v7, s[48:51], s92 offen nt
  s_add_u32 s92, s92, 8192
  buffer_load_dwordx4 v[100:103], v7, s[48:51], s92 offen nt
  s_add_u32 s92, s92, 8192
  buffer_load_dwordx4 v[104:107], v7, s[48:51], s92 offen nt
  s_add_u32 s92, s92, 8192
  buffer_load_dwordx4 v[108:111], v7, s[48:51], s92 offen nt
  s_add_u32 s92, s92, 8192
  buffer_load_dwordx4 v[112:115], v7, s[48:51], s92 offen nt
  s_add_u32 s92, s92, 8192
  buffer_load_dwordx4 v[116:119], v7, s[48:51], s92 offen nt
  s_add_u32 s92, s92, 8192
  buffer_load_dwordx4 v[120:123], v7, s[48:51], s92 offen nt
  s_add_u32 s92, s92, 8192
  buffer_load_dwordx4 v[124:127], v7, s[48:51], s92 offen nt
  s_add_u32 s92, s92, 204800
  buffer_load_dwordx4 v[128:131], v7, s[48:51], s92 offen nt
  s_add_u32 s92, s92, 8192
  buffer_load_dwordx4 v[132:135], v7, s[48:51], s92 offen nt
  s_add_u32 s92, s92, 8192
  buffer_load_dwordx4 v[136:139], v7, s[48:51], s92 offen nt
  s_add_u32 s92, s92, 8192
  buffer_load_dwordx4 v[140:143], v7, s[48:51], s92 offen nt
  s_add_u32 s92, s92, 8192
  buffer_load_dwordx4 v[144:147], v7, s[48:51], s92 offen nt
  s_add_u32 s92, s92, 8192
  buffer_load_dwordx4 v[148:151], v7, s[48:51], s92 offen nt
  s_add_u32 s92, s92, 8192
  buffer_load_dwordx4 v[152:155], v7, s[48:51], s92 offen nt
  s_add_u32 s92, s92, 8192
  buffer_load_dwordx4 v[156:159], v7, s[48:51], s92 offen nt
  s_add_u32 s92, s92, 204800
  buffer_load_dwordx4 v[160:163], v7, s[48:51], s92 offen nt
  s_add_u32 s92, s92, 8192
  buffer_load_dwordx4 v[164:167], v7, s[48:51], s92 offen nt
  s_add_u32 s92, s92, 8192
  buffer_load_dwordx4 v[168:171], v7, s[48:51], s92 offen nt
  s_add_u32 s92, s92, 8192
  buffer_load_dwordx4 v[172:175], v7, s[48:51], s92 offen nt
  s_add_u32 s92, s92, 8192
  buffer_load_dwordx4 v[176:179], v7, s[48:51], s92 offen nt
  s_add_u32 s92, s92, 8192
  buffer_load_dwordx4 v[180:183], v7, s[48:51], s92 offen nt
  s_add_u32 s92, s92, 8192
  buffer_load_dwordx4 v[184:187], v7, s[48:51], s92 offen nt
  s_add_u32 s92, s92, 8192
  buffer_load_dwordx4 v[188:191], v7, s[48:51], s92 offen nt
  v_mov_b32 v61, 1
  ds_write_b32 v60, v61 offset:4
  s_lshl_b32 s93, s6, 2
  s_add_u32 s93, s93, s7
  s_lshl_b32 s93, s93, 11
  s_add_u32 s93, s93, 266240
  s_waitcnt vmcnt(24)
  v_perm_b32 v192, v68, v64, s10
  v_perm_b32 v196, v68, v64, s11
  v_perm_b32 v193, v76, v72, s10
  v_perm_b32 v197, v76, v72, s11
  v_perm_b32 v194, v84, v80, s10
  v_perm_b32 v198, v84, v80, s11
  v_perm_b32 v195, v92, v88, s10
  v_perm_b32 v199, v92, v88, s11
  v_perm_b32 v200, v69, v65, s10
  v_perm_b32 v204, v69, v65, s11
  v_perm_b32 v201, v77, v73, s10
  v_perm_b32 v205, v77, v73, s11
  v_perm_b32 v202, v85, v81, s10
  v_perm_b32 v206, v85, v81, s11
  v_perm_b32 v203, v93, v89, s10
  v_perm_b32 v207, v93, v89, s11
  v_perm_b32 v208, v70, v66, s10
  v_perm_b32 v212, v70, v66, s11
  v_perm_b32 v209, v78, v74, s10
  v_perm_b32 v213, v78, v74, s11
  v_perm_b32 v210, v86, v82, s10
  v_perm_b32 v214, v86, v82, s11
  v_perm_b32 v211, v94, v90, s10
  v_perm_b32 v215, v94, v90, s11
  v_perm_b32 v216, v71, v67, s10
  v_perm_b32 v220, v71, v67, s11
  v_perm_b32 v217, v79, v75, s10
  v_perm_b32 v221, v79, v75, s11
  v_perm_b32 v218, v87, v83, s10
  v_perm_b32 v222, v87, v83, s11
  v_perm_b32 v219, v95, v91, s10
  v_perm_b32 v223, v95, v91, s11
  v_mfma_f32_16x16x32_bf16 v[224:227], v[16:19], v[192:195], 0
  v_mfma_f32_16x16x32_bf16 v[228:231], v[16:19], v[196:199], 0
  v_mfma_f32_16x16x32_bf16 v[232:235], v[16:19], v[200:203], 0
  v_mfma_f32_16x16x32_bf16 v[236:239], v[16:19], v[204:207], 0
  v_mfma_f32_16x16x32_bf16 v[240:243], v[16:19], v[208:211], 0
  v_mfma_f32_16x16x32_bf16 v[244:247], v[16:19], v[212:215], 0
  v_mfma_f32_16x16x32_bf16 v[248:251], v[16:19], v[216:219], 0
  v_mfma_f32_16x16x32_bf16 v[252:255], v[16:19], v[220:223], 0
  s_waitcnt vmcnt(16)
  v_perm_b32 v64, v100, v96, s10
  v_perm_b32 v68, v100, v96, s11
  v_perm_b32 v65, v108, v104, s10
  v_perm_b32 v69, v108, v104, s11
  v_perm_b32 v66, v116, v112, s10
  v_perm_b32 v70, v116, v112, s11
  v_perm_b32 v67, v124, v120, s10
  v_perm_b32 v71, v124, v120, s11
  v_perm_b32 v72, v101, v97, s10
  v_perm_b32 v76, v101, v97, s11
  v_perm_b32 v73, v109, v105, s10
  v_perm_b32 v77, v109, v105, s11
  v_perm_b32 v74, v117, v113, s10
  v_perm_b32 v78, v117, v113, s11
  v_perm_b32 v75, v125, v121, s10
  v_perm_b32 v79, v125, v121, s11
  v_perm_b32 v80, v102, v98, s10
  v_perm_b32 v84, v102, v98, s11
  v_perm_b32 v81, v110, v106, s10
  v_perm_b32 v85, v110, v106, s11
  v_perm_b32 v82, v118, v114, s10
  v_perm_b32 v86, v118, v114, s11
  v_perm_b32 v83, v126, v122, s10
  v_perm_b32 v87, v126, v122, s11
  v_perm_b32 v88, v103, v99, s10
  v_perm_b32 v92, v103, v99, s11
  v_perm_b32 v89, v111, v107, s10
  v_perm_b32 v93, v111, v107, s11
  v_perm_b32 v90, v119, v115, s10
  v_perm_b32 v94, v119, v115, s11
  v_perm_b32 v91, v127, v123, s10
  v_perm_b32 v95, v127, v123, s11
  v_mfma_f32_16x16x32_bf16 v[224:227], v[20:23], v[64:67], v[224:227]
  v_mfma_f32_16x16x32_bf16 v[228:231], v[20:23], v[68:71], v[228:231]
  v_mfma_f32_16x16x32_bf16 v[232:235], v[20:23], v[72:75], v[232:235]
  v_mfma_f32_16x16x32_bf16 v[236:239], v[20:23], v[76:79], v[236:239]
  v_mfma_f32_16x16x32_bf16 v[240:243], v[20:23], v[80:83], v[240:243]
  v_mfma_f32_16x16x32_bf16 v[244:247], v[20:23], v[84:87], v[244:247]
  v_mfma_f32_16x16x32_bf16 v[248:251], v[20:23], v[88:91], v[248:251]
  v_mfma_f32_16x16x32_bf16 v[252:255], v[20:23], v[92:95], v[252:255]
  s_waitcnt vmcnt(8)
  v_perm_b32 v96, v132, v128, s10
  v_perm_b32 v100, v132, v128, s11
  v_perm_b32 v97, v140, v136, s10
  v_perm_b32 v101, v140, v136, s11
  v_perm_b32 v98, v148, v144, s10
  v_perm_b32 v102, v148, v144, s11
  v_perm_b32 v99, v156, v152, s10
  v_perm_b32 v103, v156, v152, s11
  v_perm_b32 v104, v133, v129, s10
  v_perm_b32 v108, v133, v129, s11
  v_perm_b32 v105, v141, v137, s10
  v_perm_b32 v109, v141, v137, s11
  v_perm_b32 v106, v149, v145, s10
  v_perm_b32 v110, v149, v145, s11
  v_perm_b32 v107, v157, v153, s10
  v_perm_b32 v111, v157, v153, s11
  v_perm_b32 v112, v134, v130, s10
  v_perm_b32 v116, v134, v130, s11
  v_perm_b32 v113, v142, v138, s10
  v_perm_b32 v117, v142, v138, s11
  v_perm_b32 v114, v150, v146, s10
  v_perm_b32 v118, v150, v146, s11
  v_perm_b32 v115, v158, v154, s10
  v_perm_b32 v119, v158, v154, s11
  v_perm_b32 v120, v135, v131, s10
  v_perm_b32 v124, v135, v131, s11
  v_perm_b32 v121, v143, v139, s10
  v_perm_b32 v125, v143, v139, s11
  v_perm_b32 v122, v151, v147, s10
  v_perm_b32 v126, v151, v147, s11
  v_perm_b32 v123, v159, v155, s10
  v_perm_b32 v127, v159, v155, s11
  v_mfma_f32_16x16x32_bf16 v[224:227], v[24:27], v[96:99], v[224:227]
  v_mfma_f32_16x16x32_bf16 v[228:231], v[24:27], v[100:103], v[228:231]
  v_mfma_f32_16x16x32_bf16 v[232:235], v[24:27], v[104:107], v[232:235]
  v_mfma_f32_16x16x32_bf16 v[236:239], v[24:27], v[108:111], v[236:239]
  v_mfma_f32_16x16x32_bf16 v[240:243], v[24:27], v[112:115], v[240:243]
  v_mfma_f32_16x16x32_bf16 v[244:247], v[24:27], v[116:119], v[244:247]
  v_mfma_f32_16x16x32_bf16 v[248:251], v[24:27], v[120:123], v[248:251]
  v_mfma_f32_16x16x32_bf16 v[252:255], v[24:27], v[124:127], v[252:255]
  s_waitcnt vmcnt(0)
  v_mov_b32 v2, 133136
  ds_read_b32 v2, v2
  s_waitcnt lgkmcnt(0)
  v_readfirstlane_b32 s97, v2
  v_perm_b32 v128, v164, v160, s10
  v_perm_b32 v132, v164, v160, s11
  v_perm_b32 v129, v172, v168, s10
  v_perm_b32 v133, v172, v168, s11
  v_perm_b32 v130, v180, v176, s10
  v_perm_b32 v134, v180, v176, s11
  v_perm_b32 v131, v188, v184, s10
  v_perm_b32 v135, v188, v184, s11
  v_perm_b32 v136, v165, v161, s10
  v_perm_b32 v140, v165, v161, s11
  v_perm_b32 v137, v173, v169, s10
  v_perm_b32 v141, v173, v169, s11
  v_perm_b32 v138, v181, v177, s10
  v_perm_b32 v142, v181, v177, s11
  v_perm_b32 v139, v189, v185, s10
  v_perm_b32 v143, v189, v185, s11
  v_perm_b32 v144, v166, v162, s10
  v_perm_b32 v148, v166, v162, s11
  v_perm_b32 v145, v174, v170, s10
  v_perm_b32 v149, v174, v170, s11
  v_perm_b32 v146, v182, v178, s10
  v_perm_b32 v150, v182, v178, s11
  v_perm_b32 v147, v190, v186, s10
  v_perm_b32 v151, v190, v186, s11
  v_perm_b32 v152, v167, v163, s10
  v_perm_b32 v156, v167, v163, s11
  v_perm_b32 v153, v175, v171, s10
  v_perm_b32 v157, v175, v171, s11
  v_perm_b32 v154, v183, v179, s10
  v_perm_b32 v158, v183, v179, s11
  v_perm_b32 v155, v191, v187, s10
  v_perm_b32 v159, v191, v187, s11
  v_mfma_f32_16x16x32_bf16 v[224:227], v[28:31], v[128:131], v[224:227]
  v_mfma_f32_16x16x32_bf16 v[228:231], v[28:31], v[132:135], v[228:231]
  v_mfma_f32_16x16x32_bf16 v[232:235], v[28:31], v[136:139], v[232:235]
  v_mfma_f32_16x16x32_bf16 v[236:239], v[28:31], v[140:143], v[236:239]
  v_mfma_f32_16x16x32_bf16 v[240:243], v[28:31], v[144:147], v[240:243]
  v_mfma_f32_16x16x32_bf16 v[244:247], v[28:31], v[148:151], v[244:247]
  v_mfma_f32_16x16x32_bf16 v[248:251], v[28:31], v[152:155], v[248:251]
  v_mfma_f32_16x16x32_bf16 v[252:255], v[28:31], v[156:159], v[252:255]
  v_mov_b32 v24, s61
  v_mov_b32 v25, s62
  v_mov_b32 v26, s63
  v_mov_b32 v27, s64
  v_bfi_b32 v16, s8, v24, v224
  v_bfi_b32 v17, s8, v25, v228
  v_bfi_b32 v18, s8, v26, v232
  v_bfi_b32 v19, s8, v27, v236
  v_bfi_b32 v20, s8, v24, v240
  v_bfi_b32 v21, s8, v25, v244
  v_bfi_b32 v22, s8, v26, v248
  v_bfi_b32 v23, s8, v27, v252
  s_cmp_eq_u32 s97, 1
  s_cbranch_scc0 L_slow_52
  buffer_store_dwordx4 v[16:19], v6, s[44:47], s93 offen offset:0
  buffer_store_dwordx4 v[20:23], v6, s[44:47], s93 offen offset:1024
  s_branch L_stend_53
L_slow_52:
  buffer_store_dwordx4 v[16:19], v6, s[44:47], s93 offen offset:0 sc1
  buffer_store_dwordx4 v[20:23], v6, s[44:47], s93 offen offset:1024 sc1
L_stend_53:
  v_lshlrev_b32 v7, 13, v5
  v_lshl_add_u32 v7, v4, 4, v7
  s_lshr_b32 s12, s5, 2
  s_lshl_b32 s12, s12, 8
  s_lshl_b32 s94, s4, 15
  s_add_u32 s94, s94, s12
  s_add_u32 s94, s94, 266240
  s_add_u32 s95, s94, 4096
  s_mov_b32 s69, 0
L_spl_54:
  buffer_load_dwordx4 v[32:35], v7, s[44:47], s94 offen offset:0 sc1
  buffer_load_dwordx4 v[36:39], v7, s[44:47], s94 offen offset:1024 sc1
  buffer_load_dwordx4 v[40:43], v7, s[44:47], s94 offen offset:2048 sc1
  buffer_load_dwordx4 v[44:47], v7, s[44:47], s94 offen offset:3072 sc1
  buffer_load_dwordx4 v[48:51], v7, s[44:47], s95 offen offset:0 sc1
  buffer_load_dwordx4 v[52:55], v7, s[44:47], s95 offen offset:1024 sc1
  buffer_load_dwordx4 v[56:59], v7, s[44:47], s95 offen offset:2048 sc1
  buffer_load_dwordx4 v[60:63], v7, s[44:47], s95 offen offset:3072 sc1
  s_waitcnt vmcnt(7)
  v_xor_b32 v32, s61, v32
  v_xor_b32 v33, s62, v33
  v_xor_b32 v34, s63, v34
  v_xor_b32 v35, s64, v35
  v_or_b32 v1, v32, v33
  v_or3_b32 v1, v1, v34, v35
  v_mov_b32 v16, v32
  v_mov_b32 v17, v33
  v_mov_b32 v18, v34
  v_mov_b32 v19, v35
  s_waitcnt vmcnt(6)
  v_xor_b32 v36, s61, v36
  v_xor_b32 v37, s62, v37
  v_xor_b32 v38, s63, v38
  v_xor_b32 v39, s64, v39
  v_or3_b32 v1, v1, v36, v37
  v_or3_b32 v1, v1, v38, v39
  v_mov_b32 v20, v36
  v_mov_b32 v21, v37
  v_mov_b32 v22, v38
  v_mov_b32 v23, v39
  s_waitcnt vmcnt(5)
  v_xor_b32 v40, s61, v40
  v_xor_b32 v41, s62, v41
  v_xor_b32 v42, s63, v42
  v_xor_b32 v43, s64, v43
  v_or3_b32 v1, v1, v40, v41
  v_or3_b32 v1, v1, v42, v43
  v_add_f32 v16, v16, v40
  v_add_f32 v17, v17, v41
  v_add_f32 v18, v18, v42
  v_add_f32 v19, v19, v43
  s_waitcnt vmcnt(4)
  v_xor_b32 v44, s61, v44
  v_xor_b32 v45, s62, v45
  v_xor_b32 v46, s63, v46
  v_xor_b32 v47, s64, v47
  v_or3_b32 v1, v1, v44, v45
  v_or3_b32 v1, v1, v46, v47
  v_add_f32 v20, v20, v44
  v_add_f32 v21, v21, v45
  v_add_f32 v22, v22, v46
  v_add_f32 v23, v23, v47
  s_waitcnt vmcnt(3)
  v_xor_b32 v48, s61, v48
  v_xor_b32 v49, s62, v49
  v_xor_b32 v50, s63, v50
  v_xor_b32 v51, s64, v51
  v_or3_b32 v1, v1, v48, v49
  v_or3_b32 v1, v1, v50, v51
  v_add_f32 v16, v16, v48
  v_add_f32 v17, v17, v49
  v_add_f32 v18, v18, v50
  v_add_f32 v19, v19, v51
  s_waitcnt vmcnt(2)
  v_xor_b32 v52, s61, v52
  v_xor_b32 v53, s62, v53
  v_xor_b32 v54, s63, v54
  v_xor_b32 v55, s64, v55
  v_or3_b32 v1, v1, v52, v53
  v_or3_b32 v1, v1, v54, v55
  v_add_f32 v20, v20, v52
  v_add_f32 v21, v21, v53
  v_add_f32 v22, v22, v54
  v_add_f32 v23, v23, v55
  s_waitcnt vmcnt(1)
  v_xor_b32 v56, s61, v56
  v_xor_b32 v57, s62, v57
  v_xor_b32 v58, s63, v58
  v_xor_b32 v59, s64, v59
  v_or3_b32 v1, v1, v56, v57
  v_or3_b32 v1, v1, v58, v59
  v_add_f32 v16, v16, v56
  v_add_f32 v17, v17, v57
  v_add_f32 v18, v18, v58
  v_add_f32 v19, v19, v59
  s_waitcnt vmcnt(0)
  v_xor_b32 v60, s61, v60
  v_xor_b32 v61, s62, v61
  v_xor_b32 v62, s63, v62
  v_xor_b32 v63, s64, v63
  v_or3_b32 v1, v1, v60, v61
  v_or3_b32 v1, v1, v62, v63
  v_add_f32 v20, v20, v60
  v_add_f32 v21, v21, v61
  v_add_f32 v22, v22, v62
  v_add_f32 v23, v23, v63
  v_and_b32 v1, s8, v1
  v_cmp_ne_u32 vcc, 0, v1
  s_cbranch_vccz L_spd_55
  s_sleep 1
  s_add_u32 s69, s69, 1
  s_cmp_lt_u32 s69, 65536
  s_cbranch_scc1 L_spl_54
  s_mov_b32 s12, s40
  s_mov_b32 s13, s41
  s_mov_b32 s14, 256
  s_mov_b32 s15, 0x20000
  v_mov_b32 v2, 8
  v_mov_b32 v3, s2
  v_or_b32 v3, 0x10000, v3
  buffer_store_dword v3, v2, s[12:15], 0 offen
  s_waitcnt vmcnt(0)
L_spd_55:
  s_nop 1
  v_cvt_pk_bf16_f32 v12, v16, v17
  v_cvt_pk_bf16_f32 v13, v18, v19
  v_cvt_pk_bf16_f32 v14, v20, v21
  v_cvt_pk_bf16_f32 v15, v22, v23
  v_add_u32 v9, 131072, v6
  ds_write_b128 v9, v[12:15]
  v_mov_b32 v10, 133120
  v_mov_b32 v11, 1
  s_waitcnt lgkmcnt(0)
  ds_write_b32 v10, v11
  s_waitcnt lgkmcnt(0)
  s_endpgm
L_xg:
  s_nop 1
  s_mov_b32 s48, s24
  s_mov_b32 s49, s25
  s_mov_b32 s50, 4194304
  s_mov_b32 s51, 0x20000
  v_lshlrev_b32 v7, 16, v5
  v_lshl_add_u32 v7, v4, 4, v7
  s_lshl_b32 s92, s7, 20
  s_lshl_b32 s12, s6, 8
  s_add_u32 s92, s92, s12
  s_barrier
  buffer_load_dwordx4 v[64:67], v7, s[48:51], s92 offen nt
  s_add_u32 s92, s92, 8192
  buffer_load_dwordx4 v[68:71], v7, s[48:51], s92 offen nt
  s_add_u32 s92, s92, 8192
  buffer_load_dwordx4 v[72:75], v7, s[48:51], s92 offen nt
  s_add_u32 s92, s92, 8192
  buffer_load_dwordx4 v[76:79], v7, s[48:51], s92 offen nt
  s_add_u32 s92, s92, 8192
  buffer_load_dwordx4 v[80:83], v7, s[48:51], s92 offen nt
  s_add_u32 s92, s92, 8192
  buffer_load_dwordx4 v[84:87], v7, s[48:51], s92 offen nt
  s_add_u32 s92, s92, 8192
  buffer_load_dwordx4 v[88:91], v7, s[48:51], s92 offen nt
  s_add_u32 s92, s92, 8192
  buffer_load_dwordx4 v[92:95], v7, s[48:51], s92 offen nt
  s_add_u32 s92, s92, 204800
  buffer_load_dwordx4 v[96:99], v7, s[48:51], s92 offen nt
  s_add_u32 s92, s92, 8192
  buffer_load_dwordx4 v[100:103], v7, s[48:51], s92 offen nt
  s_add_u32 s92, s92, 8192
  buffer_load_dwordx4 v[104:107], v7, s[48:51], s92 offen nt
  s_add_u32 s92, s92, 8192
  buffer_load_dwordx4 v[108:111], v7, s[48:51], s92 offen nt
  s_add_u32 s92, s92, 8192
  buffer_load_dwordx4 v[112:115], v7, s[48:51], s92 offen nt
  s_add_u32 s92, s92, 8192
  buffer_load_dwordx4 v[116:119], v7, s[48:51], s92 offen nt
  s_add_u32 s92, s92, 8192
  buffer_load_dwordx4 v[120:123], v7, s[48:51], s92 offen nt
  s_add_u32 s92, s92, 8192
  buffer_load_dwordx4 v[124:127], v7, s[48:51], s92 offen nt
  s_add_u32 s92, s92, 204800
  buffer_load_dwordx4 v[128:131], v7, s[48:51], s92 offen nt
  s_add_u32 s92, s92, 8192
  buffer_load_dwordx4 v[132:135], v7, s[48:51], s92 offen nt
  s_add_u32 s92, s92, 8192
  buffer_load_dwordx4 v[136:139], v7, s[48:51], s92 offen nt
  s_add_u32 s92, s92, 8192
  buffer_load_dwordx4 v[140:143], v7, s[48:51], s92 offen nt
  s_add_u32 s92, s92, 8192
  buffer_load_dwordx4 v[144:147], v7, s[48:51], s92 offen nt
  s_add_u32 s92, s92, 8192
  buffer_load_dwordx4 v[148:151], v7, s[48:51], s92 offen nt
  s_add_u32 s92, s92, 8192
  buffer_load_dwordx4 v[152:155], v7, s[48:51], s92 offen nt
  s_add_u32 s92, s92, 8192
  buffer_load_dwordx4 v[156:159], v7, s[48:51], s92 offen nt
  s_add_u32 s92, s92, 204800
  buffer_load_dwordx4 v[160:163], v7, s[48:51], s92 offen nt
  s_add_u32 s92, s92, 8192
  buffer_load_dwordx4 v[164:167], v7, s[48:51], s92 offen nt
  s_add_u32 s92, s92, 8192
  buffer_load_dwordx4 v[168:171], v7, s[48:51], s92 offen nt
  s_add_u32 s92, s92, 8192
  buffer_load_dwordx4 v[172:175], v7, s[48:51], s92 offen nt
  s_add_u32 s92, s92, 8192
  buffer_load_dwordx4 v[176:179], v7, s[48:51], s92 offen nt
  s_add_u32 s92, s92, 8192
  buffer_load_dwordx4 v[180:183], v7, s[48:51], s92 offen nt
  s_add_u32 s92, s92, 8192
  buffer_load_dwordx4 v[184:187], v7, s[48:51], s92 offen nt
  s_add_u32 s92, s92, 8192
  buffer_load_dwordx4 v[188:191], v7, s[48:51], s92 offen nt
  s_barrier
  s_barrier
  s_waitcnt vmcnt(24)
  v_perm_b32 v192, v68, v64, s10
  v_perm_b32 v196, v68, v64, s11
  v_perm_b32 v193, v76, v72, s10
  v_perm_b32 v197, v76, v72, s11
  v_perm_b32 v194, v84, v80, s10
  v_perm_b32 v198, v84, v80, s11
  v_perm_b32 v195, v92, v88, s10
  v_perm_b32 v199, v92, v88, s11
  v_perm_b32 v200, v69, v65, s10
  v_perm_b32 v204, v69, v65, s11
  v_perm_b32 v201, v77, v73, s10
  v_perm_b32 v205, v77, v73, s11
  v_perm_b32 v202, v85, v81, s10
  v_perm_b32 v206, v85, v81, s11
  v_perm_b32 v203, v93, v89, s10
  v_perm_b32 v207, v93, v89, s11
  v_perm_b32 v208, v70, v66, s10
  v_perm_b32 v212, v70, v66, s11
  v_perm_b32 v209, v78, v74, s10
  v_perm_b32 v213, v78, v74, s11
  v_perm_b32 v210, v86, v82, s10
  v_perm_b32 v214, v86, v82, s11
  v_perm_b32 v211, v94, v90, s10
  v_perm_b32 v215, v94, v90, s11
  v_perm_b32 v216, v71, v67, s10
  v_perm_b32 v220, v71, v67, s11
  v_perm_b32 v217, v79, v75, s10
  v_perm_b32 v221, v79, v75, s11
  v_perm_b32 v218, v87, v83, s10
  v_perm_b32 v222, v87, v83, s11
  v_perm_b32 v219, v95, v91, s10
  v_perm_b32 v223, v95, v91, s11
  s_waitcnt vmcnt(16)
  v_perm_b32 v64, v100, v96, s10
  v_perm_b32 v68, v100, v96, s11
  v_perm_b32 v65, v108, v104, s10
  v_perm_b32 v69, v108, v104, s11
  v_perm_b32 v66, v116, v112, s10
  v_perm_b32 v70, v116, v112, s11
  v_perm_b32 v67, v124, v120, s10
  v_perm_b32 v71, v124, v120, s11
  v_perm_b32 v72, v101, v97, s10
  v_perm_b32 v76, v101, v97, s11
  v_perm_b32 v73, v109, v105, s10
  v_perm_b32 v77, v109, v105, s11
  v_perm_b32 v74, v117, v113, s10
  v_perm_b32 v78, v117, v113, s11
  v_perm_b32 v75, v125, v121, s10
  v_perm_b32 v79, v125, v121, s11
  v_perm_b32 v80, v102, v98, s10
  v_perm_b32 v84, v102, v98, s11
  v_perm_b32 v81, v110, v106, s10
  v_perm_b32 v85, v110, v106, s11
  v_perm_b32 v82, v118, v114, s10
  v_perm_b32 v86, v118, v114, s11
  v_perm_b32 v83, v126, v122, s10
  v_perm_b32 v87, v126, v122, s11
  v_perm_b32 v88, v103, v99, s10
  v_perm_b32 v92, v103, v99, s11
  v_perm_b32 v89, v111, v107, s10
  v_perm_b32 v93, v111, v107, s11
  v_perm_b32 v90, v119, v115, s10
  v_perm_b32 v94, v119, v115, s11
  v_perm_b32 v91, v127, v123, s10
  v_perm_b32 v95, v127, v123, s11
  s_waitcnt vmcnt(8)
  v_perm_b32 v96, v132, v128, s10
  v_perm_b32 v100, v132, v128, s11
  v_perm_b32 v97, v140, v136, s10
  v_perm_b32 v101, v140, v136, s11
  v_perm_b32 v98, v148, v144, s10
  v_perm_b32 v102, v148, v144, s11
  v_perm_b32 v99, v156, v152, s10
  v_perm_b32 v103, v156, v152, s11
  v_perm_b32 v104, v133, v129, s10
  v_perm_b32 v108, v133, v129, s11
  v_perm_b32 v105, v141, v137, s10
  v_perm_b32 v109, v141, v137, s11
  v_perm_b32 v106, v149, v145, s10
  v_perm_b32 v110, v149, v145, s11
  v_perm_b32 v107, v157, v153, s10
  v_perm_b32 v111, v157, v153, s11
  v_perm_b32 v112, v134, v130, s10
  v_perm_b32 v116, v134, v130, s11
  v_perm_b32 v113, v142, v138, s10
  v_perm_b32 v117, v142, v138, s11
  v_perm_b32 v114, v150, v146, s10
  v_perm_b32 v118, v150, v146, s11
  v_perm_b32 v115, v158, v154, s10
  v_perm_b32 v119, v158, v154, s11
  v_perm_b32 v120, v135, v131, s10
  v_perm_b32 v124, v135, v131, s11
  v_perm_b32 v121, v143, v139, s10
  v_perm_b32 v125, v143, v139, s11
  v_perm_b32 v122, v151, v147, s10
  v_perm_b32 v126, v151, v147, s11
  v_perm_b32 v123, v159, v155, s10
  v_perm_b32 v127, v159, v155, s11
  s_waitcnt vmcnt(0)
  v_perm_b32 v128, v164, v160, s10
  v_perm_b32 v132, v164, v160, s11
  v_perm_b32 v129, v172, v168, s10
  v_perm_b32 v133, v172, v168, s11
  v_perm_b32 v130, v180, v176, s10
  v_perm_b32 v134, v180, v176, s11
  v_perm_b32 v131, v188, v184, s10
  v_perm_b32 v135, v188, v184, s11
  v_perm_b32 v136, v165, v161, s10
  v_perm_b32 v140, v165, v161, s11
  v_perm_b32 v137, v173, v169, s10
  v_perm_b32 v141, v173, v169, s11
  v_perm_b32 v138, v181, v177, s10
  v_perm_b32 v142, v181, v177, s11
  v_perm_b32 v139, v189, v185, s10
  v_perm_b32 v143, v189, v185, s11
  v_perm_b32 v144, v166, v162, s10
  v_perm_b32 v148, v166, v162, s11
  v_perm_b32 v145, v174, v170, s10
  v_perm_b32 v149, v174, v170, s11
  v_perm_b32 v146, v182, v178, s10
  v_perm_b32 v150, v182, v178, s11
  v_perm_b32 v147, v190, v186, s10
  v_perm_b32 v151, v190, v186, s11
  v_perm_b32 v152, v167, v163, s10
  v_perm_b32 v156, v167, v163, s11
  v_perm_b32 v153, v175, v171, s10
  v_perm_b32 v157, v175, v171, s11
  v_perm_b32 v154, v183, v179, s10
  v_perm_b32 v158, v183, v179, s11
  v_perm_b32 v155, v191, v187, s10
  v_perm_b32 v159, v191, v187, s11
  v_add_u32 v9, 142336, v6
  v_lshrrev_b32 v10, 2, v4
  v_lshlrev_b32 v10, 8, v10
  v_lshl_add_u32 v10, v5, 4, v10
  v_add_u32 v10, 142336, v10
  s_lshl_b32 s94, s6, 2
  s_add_u32 s94, s94, s7
  s_lshl_b32 s94, s94, 11
  s_add_u32 s94, s94, 724992
  v_lshlrev_b32 v11, 17, v5
  v_bfe_u32 v12, v0, 2, 2
  v_lshl_add_u32 v11, v12, 12, v11
  v_and_b32 v12, 3, v0
  v_lshl_add_u32 v11, v12, 7, v11
  v_lshlrev_b32 v8, 14, v5
  s_lshl_b32 s92, s7, 14
  s_lshr_b32 s12, s6, 2
  s_lshl_b32 s12, s12, 9
  s_add_u32 s92, s92, s12
  s_and_b32 s12, s6, 3
  s_lshl_b32 s12, s12, 4
  s_add_u32 s92, s92, s12
  s_add_u32 s92, s92, 6553600
  s_add_u32 s93, s92, 65536
  s_lshl_b32 s95, s7, 11
  s_lshl_b32 s12, s6, 4
  s_add_u32 s95, s95, s12
  s_add_u32 s95, s95, 7077888
  s_add_u32 s96, s95, 8192
  v_mov_b32 v60, 141312
  buffer_load_dword v3, v11, s[44:47], s92 offen
  buffer_load_dword v3, v8, s[44:47], s95 offen
  buffer_load_dword v3, v11, s[44:47], s93 offen
  buffer_load_dword v3, v8, s[44:47], s96 offen
  v_mov_b32 v2, 141328
  ds_read_b32 v2, v2
  s_waitcnt lgkmcnt(0)
  v_readfirstlane_b32 s97, v2
  s_mov_b32 s69, 0
L_lspin_56:
  ds_read_b32 v61, v60 offset:0
  s_waitcnt lgkmcnt(0)
  v_cmp_ne_u32 vcc, 4, v61
  s_cbranch_vccz L_ldone_57
  s_add_u32 s69, s69, 1
  s_cmp_lt_u32 s69, 4194304
  s_cbranch_scc1 L_lspin_56
  s_mov_b32 s12, s40
  s_mov_b32 s13, s41
  s_mov_b32 s14, 256
  s_mov_b32 s15, 0x20000
  v_mov_b32 v2, 88
  v_mov_b32 v3, s2
  v_or_b32 v3, 0x10000, v3
  buffer_store_dword v3, v2, s[12:15], 0 offen
  s_waitcnt vmcnt(0)
L_ldone_57:
  s_nop 1
  s_mov_b32 s69, 0
L_spl_58:
  buffer_load_dwordx4 v[48:51], v8, s[44:47], s95 offen sc1
  buffer_load_dwordx4 v[52:55], v8, s[44:47], s96 offen sc1
  buffer_load_dwordx4 v[32:35], v11, s[44:47], s92 offen offset:0 sc1
  buffer_load_dwordx4 v[36:39], v11, s[44:47], s92 offen offset:64 sc1
  buffer_load_dwordx4 v[40:43], v11, s[44:47], s93 offen offset:0 sc1
  buffer_load_dwordx4 v[44:47], v11, s[44:47], s93 offen offset:64 sc1
  s_waitcnt vmcnt(5)
  v_xor_b32 v48, s61, v48
  v_xor_b32 v49, s62, v49
  v_xor_b32 v50, s63, v50
  v_xor_b32 v51, s64, v51
  v_or_b32 v1, v48, v49
  v_or3_b32 v1, v1, v50, v51
  s_waitcnt vmcnt(4)
  v_xor_b32 v52, s61, v52
  v_xor_b32 v53, s62, v53
  v_xor_b32 v54, s63, v54
  v_xor_b32 v55, s64, v55
  v_or3_b32 v1, v1, v52, v53
  v_or3_b32 v1, v1, v54, v55
  v_max_f32 v24, v48, v52
  v_sub_f32 v25, v48, v24
  v_sub_f32 v26, v52, v24
  v_exp_f32 v25, v25
  v_exp_f32 v26, v26
  v_mul_f32 v27, v25, v49
  v_fmac_f32 v27, v26, v53
  v_rcp_f32 v27, v27
  s_nop 0
  v_mul_f32 v25, v25, v27
  v_mul_f32 v26, v26, v27
  s_waitcnt vmcnt(3)
  v_xor_b32 v32, s61, v32
  v_xor_b32 v33, s62, v33
  v_xor_b32 v34, s63, v34
  v_xor_b32 v35, s64, v35
  v_or3_b32 v1, v1, v32, v33
  v_or3_b32 v1, v1, v34, v35
  v_mul_f32 v16, v25, v32
  v_mul_f32 v17, v25, v33
  v_mul_f32 v18, v25, v34
  v_mul_f32 v19, v25, v35
  s_waitcnt vmcnt(2)
  v_xor_b32 v36, s61, v36
  v_xor_b32 v37, s62, v37
  v_xor_b32 v38, s63, v38
  v_xor_b32 v39, s64, v39
  v_or3_b32 v1, v1, v36, v37
  v_or3_b32 v1, v1, v38, v39
  v_mul_f32 v20, v25, v36
  v_mul_f32 v21, v25, v37
  v_mul_f32 v22, v25, v38
  v_mul_f32 v23, v25, v39
  s_waitcnt vmcnt(1)
  v_xor_b32 v40, s61, v40
  v_xor_b32 v41, s62, v41
  v_xor_b32 v42, s63, v42
  v_xor_b32 v43, s64, v43
  v_or3_b32 v1, v1, v40, v41
  v_or3_b32 v1, v1, v42, v43
  v_fmac_f32 v16, v26, v40
  v_fmac_f32 v17, v26, v41
  v_fmac_f32 v18, v26, v42
  v_fmac_f32 v19, v26, v43
  s_waitcnt vmcnt(0)
  v_xor_b32 v44, s61, v44
  v_xor_b32 v45, s62, v45
  v_xor_b32 v46, s63, v46
  v_xor_b32 v47, s64, v47
  v_or3_b32 v1, v1, v44, v45
  v_or3_b32 v1, v1, v46, v47
  v_fmac_f32 v20, v26, v44
  v_fmac_f32 v21, v26, v45
  v_fmac_f32 v22, v26, v46
  v_fmac_f32 v23, v26, v47
  v_and_b32 v1, s8, v1
  v_cmp_ne_u32 vcc, 0, v1
  s_cbranch_vccz L_spd_59
  s_sleep 1
  s_add_u32 s69, s69, 1
  s_cmp_lt_u32 s69, 65536
  s_cbranch_scc1 L_spl_58
  s_mov_b32 s12, s40
  s_mov_b32 s13, s41
  s_mov_b32 s14, 256
  s_mov_b32 s15, 0x20000
  v_mov_b32 v2, 40
  v_mov_b32 v3, s2
  v_or_b32 v3, 0x10000, v3
  buffer_store_dword v3, v2, s[12:15], 0 offen
  s_waitcnt vmcnt(0)
L_spd_59:
  s_nop 1
  v_cvt_pk_bf16_f32 v12, v16, v17
  v_cvt_pk_bf16_f32 v13, v18, v19
  v_cvt_pk_bf16_f32 v14, v20, v21
  v_cvt_pk_bf16_f32 v15, v22, v23
  ds_write_b128 v9, v[12:15]
  ds_read_b128 v[16:19], v10 offset:0
  ds_read_b128 v[20:23], v10 offset:64
  ds_read_b128 v[24:27], v10 offset:128
  ds_read_b128 v[28:31], v10 offset:192
  s_waitcnt lgkmcnt(0)
  v_mfma_f32_16x16x32_bf16 v[224:227], v[16:19], v[192:195], 0
  v_mfma_f32_16x16x32_bf16 v[228:231], v[16:19], v[196:199], 0
  v_mfma_f32_16x16x32_bf16 v[232:235], v[16:19], v[200:203], 0
  v_mfma_f32_16x16x32_bf16 v[236:239], v[16:19], v[204:207], 0
  v_mfma_f32_16x16x32_bf16 v[240:243], v[16:19], v[208:211], 0
  v_mfma_f32_16x16x32_bf16 v[244:247], v[16:19], v[212:215], 0
  v_mfma_f32_16x16x32_bf16 v[248:251], v[16:19], v[216:219], 0
  v_mfma_f32_16x16x32_bf16 v[252:255], v[16:19], v[220:223], 0
  v_mfma_f32_16x16x32_bf16 v[224:227], v[20:23], v[64:67], v[224:227]
  v_mfma_f32_16x16x32_bf16 v[228:231], v[20:23], v[68:71], v[228:231]
  v_mfma_f32_16x16x32_bf16 v[232:235], v[20:23], v[72:75], v[232:235]
  v_mfma_f32_16x16x32_bf16 v[236:239], v[20:23], v[76:79], v[236:239]
  v_mfma_f32_16x16x32_bf16 v[240:243], v[20:23], v[80:83], v[240:243]
  v_mfma_f32_16x16x32_bf16 v[244:247], v[20:23], v[84:87], v[244:247]
  v_mfma_f32_16x16x32_bf16 v[248:251], v[20:23], v[88:91], v[248:251]
  v_mfma_f32_16x16x32_bf16 v[252:255], v[20:23], v[92:95], v[252:255]
  v_mfma_f32_16x16x32_bf16 v[224:227], v[24:27], v[96:99], v[224:227]
  v_mfma_f32_16x16x32_bf16 v[228:231], v[24:27], v[100:103], v[228:231]
  v_mfma_f32_16x16x32_bf16 v[232:235], v[24:27], v[104:107], v[232:235]
  v_mfma_f32_16x16x32_bf16 v[236:239], v[24:27], v[108:111], v[236:239]
  v_mfma_f32_16x16x32_bf16 v[240:243], v[24:27], v[112:115], v[240:243]
  v_mfma_f32_16x16x32_bf16 v[244:247], v[24:27], v[116:119], v[244:247]
  v_mfma_f32_16x16x32_bf16 v[248:251], v[24:27], v[120:123], v[248:251]
  v_mfma_f32_16x16x32_bf16 v[252:255], v[24:27], v[124:127], v[252:255]
  v_mfma_f32_16x16x32_bf16 v[224:227], v[28:31], v[128:131], v[224:227]
  v_mfma_f32_16x16x32_bf16 v[228:231], v[28:31], v[132:135], v[228:231]
  v_mfma_f32_16x16x32_bf16 v[232:235], v[28:31], v[136:139], v[232:235]
  v_mfma_f32_16x16x32_bf16 v[236:239], v[28:31], v[140:143], v[236:239]
  v_mfma_f32_16x16x32_bf16 v[240:243], v[28:31], v[144:147], v[240:243]
  v_mfma_f32_16x16x32_bf16 v[244:247], v[28:31], v[148:151], v[244:247]
  v_mfma_f32_16x16x32_bf16 v[248:251], v[28:31], v[152:155], v[248:251]
  v_mfma_f32_16x16x32_bf16 v[252:255], v[28:31], v[156:159], v[252:255]
  v_mov_b32 v24, s61
  v_mov_b32 v25, s62
  v_mov_b32 v26, s63
  v_mov_b32 v27, s64
  v_bfi_b32 v16, s8, v24, v224
  v_bfi_b32 v17, s8, v25, v228
  v_bfi_b32 v18, s8, v26, v232
  v_bfi_b32 v19, s8, v27, v236
  v_bfi_b32 v20, s8, v24, v240
  v_bfi_b32 v21, s8, v25, v244
  v_bfi_b32 v22, s8, v26, v248
  v_bfi_b32 v23, s8, v27, v252
  s_cmp_eq_u32 s97, 1
  s_cbranch_scc0 L_slow_60
  buffer_store_dwordx4 v[16:19], v6, s[44:47], s94 offen offset:0
  buffer_store_dwordx4 v[20:23], v6, s[44:47], s94 offen offset:1024
  s_branch L_stend_61
L_slow_60:
  buffer_store_dwordx4 v[16:19], v6, s[44:47], s94 offen offset:0 sc1
  buffer_store_dwordx4 v[20:23], v6, s[44:47], s94 offen offset:1024 sc1
L_stend_61:
  v_mov_b32 v61, 1
  ds_write_b32 v60, v61 offset:24
  s_endpgm
L_ya:
  s_nop 1
  s_waitcnt lgkmcnt(0)
  s_add_u32 s44, s42, 0
  s_addc_u32 s45, s43, 0
  s_mov_b32 s46, 7864320
  s_mov_b32 s47, 0x20000
  s_load_dword s60, s[44:45], 0
  s_endpgm
L_alpha:
  s_nop 1
  s_waitcnt lgkmcnt(0)
  s_add_u32 s44, s42, 0
  s_addc_u32 s45, s43, 0
  s_mov_b32 s46, 7864320
  s_mov_b32 s47, 0x20000
  s_load_dword s60, s[44:45], 0
  v_and_b32 v4, 15, v0
  v_lshrrev_b32 v5, 4, v0
  v_lshlrev_b32 v6, 4, v0
  s_waitcnt lgkmcnt(0)
  s_add_u32 s60, s60, 1
  s_and_b32 s61, s60, 0xff
  s_xor_b32 s62, s61, 0xa5
  s_lshr_b32 s63, s60, 8
  s_and_b32 s63, s63, 0xff
  s_xor_b32 s63, s63, 0x96
  s_lshr_b32 s64, s60, 16
  s_and_b32 s64, s64, 0xff
  s_xor_b32 s64, s64, s61
  s_xor_b32 s64, s64, 0x3c
  s_lshr_b32 s12, s61, 0
  s_and_b32 s12, s12, 1
  s_lshr_b32 s13, s61, 1
  s_and_b32 s13, s13, 1
  s_lshl_b32 s13, s13, 16
  s_or_b32 s65, s12, s13
  s_lshr_b32 s12, s61, 2
  s_and_b32 s12, s12, 1
  s_lshr_b32 s13, s61, 3
  s_and_b32 s13, s13, 1
  s_lshl_b32 s13, s13, 16
  s_or_b32 s66, s12, s13
  s_lshr_b32 s12, s61, 4
  s_and_b32 s12, s12, 1
  s_lshr_b32 s13, s61, 5
  s_and_b32 s13, s13, 1
  s_lshl_b32 s13, s13, 16
  s_or_b32 s67, s12, s13
  s_lshr_b32 s12, s61, 6
  s_and_b32 s12, s12, 1
  s_lshr_b32 s13, s61, 7
  s_and_b32 s13, s13, 1
  s_lshl_b32 s13, s13, 16
  s_or_b32 s68, s12, s13
  s_barrier
  s_getreg_b32 s94, hwreg(HW_REG_XCC_ID)
  s_and_b32 s94, s94, 0xffff
  s_lshl_b32 s94, s94, 8
  v_mov_b32 v40, s61
  v_mov_b32 v41, s62
  v_mov_b32 v42, s63
  v_mov_b32 v43, s64
  v_mov_b32 v16, s94
  v_mov_b32 v17, 0
  v_mov_b32 v18, 0
  v_mov_b32 v19, 0
  v_bfi_b32 v16, s8, v40, v16
  v_bfi_b32 v17, s8, v41, v17
  v_bfi_b32 v18, s8, v42, v18
  v_bfi_b32 v19, s8, v43, v19
  s_lshl_b32 s98, s4, 9
  s_add_u32 s98, s98, 7143424
  s_lshl_b32 s12, s5, 4
  s_add_u32 s93, s98, s12
  s_add_u32 s93, s93, 256
  v_mov_b32 v12, 0
  s_mov_b64 exec, 1
  buffer_store_dwordx4 v[16:19], v12, s[44:47], s93 offen sc1
  s_mov_b64 exec, -1
  v_mov_b32 v24, 163776
  s_mov_b32 s69, 0
L_lspin_62:
  ds_read_b32 v25, v24 offset:16
  s_waitcnt lgkmcnt(0)
  v_cmp_ne_u32 vcc, 4, v25
  s_cbranch_vccz L_ldone_63
  s_add_u32 s69, s69, 1
  s_cmp_lt_u32 s69, 4194304
  s_cbranch_scc1 L_lspin_62
  s_mov_b32 s12, s40
  s_mov_b32 s13, s41
  s_mov_b32 s14, 256
  s_mov_b32 s15, 0x20000
  v_mov_b32 v2, 112
  v_mov_b32 v3, s2
  v_or_b32 v3, 0x10000, v3
  buffer_store_dword v3, v2, s[12:15], 0 offen
  s_waitcnt vmcnt(0)
L_ldone_63:
  s_nop 1
  s_lshl_b32 s92, s4, 4
  s_add_u32 s92, s92, s5
  s_lshl_b32 s92, s92, 7
  s_add_u32 s92, s92, 7151616
  v_mov_b32 v16, 0
  v_mov_b32 v17, 0
  v_mov_b32 v18, 0
  v_mov_b32 v19, 0
  v_bfi_b32 v16, s8, v40, v16
  v_bfi_b32 v17, s8, v41, v17
  v_bfi_b32 v18, s8, v42, v18
  v_bfi_b32 v19, s8, v43, v19
  v_mov_b32 v12, 0
  s_mov_b64 exec, 1
  buffer_store_dwordx4 v[16:19], v12, s[44:47], s92 offen sc1
  s_mov_b64 exec, -1
  s_mov_b64 exec, 1
  v_mov_b32 v25, 1
  ds_add_u32 v24, v25 offset:20
  s_mov_b64 exec, -1
  v_and_b32 v12, 31, v0
  v_lshlrev_b32 v12, 4, v12
  s_mov_b32 s69, 0
L_poll_64:
  buffer_load_dwordx4 v[20:23], v12, s[44:47], s98 offen sc1
  s_waitcnt vmcnt(0)
  v_xor_b32 v20, s61, v20
  v_xor_b32 v21, s62, v21
  v_xor_b32 v22, s63, v22
  v_xor_b32 v23, s64, v23
  v_or_b32 v1, v20, v21
  v_or3_b32 v1, v1, v22, v23
  v_and_b32 v1, s8, v1
  v_cmp_ne_u32 vcc, 0, v1
  s_cbranch_vccz L_done_65
  s_sleep 1
  s_add_u32 s69, s69, 1
  s_cmp_lt_u32 s69, 65536
  s_cbranch_scc1 L_poll_64
  s_mov_b32 s12, s40
  s_mov_b32 s13, s41
  s_mov_b32 s14, 256
  s_mov_b32 s15, 0x20000
  v_mov_b32 v2, 76
  v_mov_b32 v3, s2
  v_or_b32 v3, 0x10000, v3
  buffer_store_dword v3, v2, s[12:15], 0 offen
  s_waitcnt vmcnt(0)
L_done_65:
  s_nop 1
  v_cmp_ne_u32 vcc, s94, v20
  s_nop 1
  s_cmp_eq_u64 vcc, 0
  s_cselect_b32 s95, 1, 2
  v_and_b32 v8, 31, v0
  v_lshrrev_b32 v9, 5, v0
  v_lshlrev_b32 v12, 4, v8
  v_lshl_add_u32 v12, v9, 9, v12
  s_lshl_b32 s92, s4, 13
  s_add_u32 s92, s92, 659456
  s_add_u32 s93, s92, 4096
  v_lshlrev_b32 v13, 2, v8
  v_lshl_add_u32 v13, v9, 7, v13
  v_add_u32 v13, 143360, v13
  v_mov_b32 v24, 141312
  s_lshl_b32 s96, s4, 4
  s_add_u32 s96, s96, s5
  s_lshl_b32 s96, s96, 9
  s_add_u32 s96, s96, 7077888
  buffer_load_dword v3, v12, s[44:47], s92 offen offset:0
  buffer_load_dword v3, v12, s[44:47], s92 offen offset:1024
  buffer_load_dword v3, v12, s[44:47], s92 offen offset:2048
  buffer_load_dword v3, v12, s[44:47], s92 offen offset:3072
  buffer_load_dword v3, v12, s[44:47], s93 offen offset:0
  buffer_load_dword v3, v12, s[44:47], s93 offen offset:1024
  buffer_load_dword v3, v12, s[44:47], s93 offen offset:2048
  buffer_load_dword v3, v12, s[44:47], s93 offen offset:3072
  s_barrier
  s_barrier
  v_mov_b32 v25, s95
  ds_write_b32 v24, v25 offset:16
  s_waitcnt lgkmcnt(0)
  s_barrier
  s_mov_b32 s69, 0
L_poll_66:
  buffer_load_dwordx4 v[64:67], v12, s[44:47], s92 offen offset:0 sc1
  buffer_load_dwordx4 v[68:71], v12, s[44:47], s92 offen offset:1024 sc1
  buffer_load_dwordx4 v[72:75], v12, s[44:47], s92 offen offset:2048 sc1
  buffer_load_dwordx4 v[76:79], v12, s[44:47], s92 offen offset:3072 sc1
  buffer_load_dwordx4 v[80:83], v12, s[44:47], s93 offen offset:0 sc1
  buffer_load_dwordx4 v[84:87], v12, s[44:47], s93 offen offset:1024 sc1
  buffer_load_dwordx4 v[88:91], v12, s[44:47], s93 offen offset:2048 sc1
  buffer_load_dwordx4 v[92:95], v12, s[44:47], s93 offen offset:3072 sc1
  s_waitcnt vmcnt(0)
  v_xor_b32 v64, s61, v64
  v_xor_b32 v65, s62, v65
  v_xor_b32 v66, s63, v66
  v_xor_b32 v67, s64, v67
  v_xor_b32 v68, s61, v68
  v_xor_b32 v69, s62, v69
  v_xor_b32 v70, s63, v70
  v_xor_b32 v71, s64, v71
  v_xor_b32 v72, s61, v72
  v_xor_b32 v73, s62, v73
  v_xor_b32 v74, s63, v74
  v_xor_b32 v75, s64, v75
  v_xor_b32 v76, s61, v76
  v_xor_b32 v77, s62, v77
  v_xor_b32 v78, s63, v78
  v_xor_b32 v79, s64, v79
  v_xor_b32 v80, s61, v80
  v_xor_b32 v81, s62, v81
  v_xor_b32 v82, s63, v82
  v_xor_b32 v83, s64, v83
  v_xor_b32 v84, s61, v84
  v_xor_b32 v85, s62, v85
  v_xor_b32 v86, s63, v86
  v_xor_b32 v87, s64, v87
  v_xor_b32 v88, s61, v88
  v_xor_b32 v89, s62, v89
  v_xor_b32 v90, s63, v90
  v_xor_b32 v91, s64, v91
  v_xor_b32 v92, s61, v92
  v_xor_b32 v93, s62, v93
  v_xor_b32 v94, s63, v94
  v_xor_b32 v95, s64, v95
  v_or_b32 v1, v64, v65
  v_or3_b32 v1, v1, v66, v67
  v_or3_b32 v1, v1, v68, v69
  v_or3_b32 v1, v1, v70, v71
  v_or3_b32 v1, v1, v72, v73
  v_or3_b32 v1, v1, v74, v75
  v_or3_b32 v1, v1, v76, v77
  v_or3_b32 v1, v1, v78, v79
  v_or3_b32 v1, v1, v80, v81
  v_or3_b32 v1, v1, v82, v83
  v_or3_b32 v1, v1, v84, v85
  v_or3_b32 v1, v1, v86, v87
  v_or3_b32 v1, v1, v88, v89
  v_or3_b32 v1, v1, v90, v91
  v_or3_b32 v1, v1, v92, v93
  v_or3_b32 v1, v1, v94, v95
  v_and_b32 v1, s8, v1
  v_cmp_ne_u32 vcc, 0, v1
  s_cbranch_vccz L_done_67
  s_sleep 1
  s_add_u32 s69, s69, 1
  s_cmp_lt_u32 s69, 65536
  s_cbranch_scc1 L_poll_66
  s_mov_b32 s12, s40
  s_mov_b32 s13, s41
  s_mov_b32 s14, 256
  s_mov_b32 s15, 0x20000
  v_mov_b32 v2, 16
  v_mov_b32 v3, s2
  v_or_b32 v3, 0x10000, v3
  buffer_store_dword v3, v2, s[12:15], 0 offen
  s_waitcnt vmcnt(0)
L_done_67:
  s_nop 1
  v_max3_f32 v30, v64, v68, v72
  v_max3_f32 v30, v30, v76, v80
  v_max3_f32 v30, v30, v84, v88
  v_max_f32 v30, v30, v92
  v_mov_b32 v31, v30
  s_nop 1
  v_permlane32_swap_b32 v30, v31
  v_max_f32 v30, v30, v31
  v_sub_f32 v44, v64, v30
  v_sub_f32 v45, v68, v30
  v_sub_f32 v46, v72, v30
  v_sub_f32 v47, v76, v30
  v_sub_f32 v48, v80, v30
  v_sub_f32 v49, v84, v30
  v_sub_f32 v50, v88, v30
  v_sub_f32 v51, v92, v30
  v_exp_f32 v44, v44
  v_exp_f32 v45, v45
  v_exp_f32 v46, v46
  v_exp_f32 v47, v47
  v_exp_f32 v48, v48
  v_exp_f32 v49, v49
  v_exp_f32 v50, v50
  v_exp_f32 v51, v51
  v_cvt_pk_bf16_f32 v44, v44, v44
  v_cvt_pk_bf16_f32 v45, v45, v45
  v_cvt_pk_bf16_f32 v46, v46, v46
  v_cvt_pk_bf16_f32 v47, v47, v47
  v_cvt_pk_bf16_f32 v48, v48, v48
  v_cvt_pk_bf16_f32 v49, v49, v49
  v_cvt_pk_bf16_f32 v50, v50, v50
  v_cvt_pk_bf16_f32 v51, v51, v51
  v_and_b32 v52, 0xffff, v44
  v_and_b32 v44, 0xffff0000, v44
  v_and_b32 v53, 0xffff, v45
  v_and_b32 v45, 0xffff0000, v45
  v_and_b32 v54, 0xffff, v46
  v_and_b32 v46, 0xffff0000, v46
  v_and_b32 v55, 0xffff, v47
  v_and_b32 v47, 0xffff0000, v47
  v_and_b32 v56, 0xffff, v48
  v_and_b32 v48, 0xffff0000, v48
  v_and_b32 v57, 0xffff, v49
  v_and_b32 v49, 0xffff0000, v49
  v_and_b32 v58, 0xffff, v50
  v_and_b32 v50, 0xffff0000, v50
  v_and_b32 v59, 0xffff, v51
  v_and_b32 v51, 0xffff0000, v51
  ds_write_b32 v13, v52 offset:0
  ds_write_b32 v13, v53 offset:256
  ds_write_b32 v13, v54 offset:512
  ds_write_b32 v13, v55 offset:768
  ds_write_b32 v13, v56 offset:1024
  ds_write_b32 v13, v57 offset:1280
  ds_write_b32 v13, v58 offset:1536
  ds_write_b32 v13, v59 offset:1792
  v_mul_f32 v31, v44, v65
  v_fmac_f32 v31, v45, v69
  v_fmac_f32 v31, v46, v73
  v_fmac_f32 v31, v47, v77
  v_fmac_f32 v31, v48, v81
  v_fmac_f32 v31, v49, v85
  v_fmac_f32 v31, v50, v89
  v_fmac_f32 v31, v51, v93
  v_mov_b32 v25, 1
  s_waitcnt lgkmcnt(0)
  ds_write_b32 v24, v25 offset:8
  v_mov_b32 v32, v31
  s_nop 1
  v_permlane32_swap_b32 v31, v32
  v_add_f32 v31, v31, v32
  v_mov_b32 v16, v30
  v_mov_b32 v17, v31
  v_mov_b32 v18, 0
  v_mov_b32 v19, 0
  v_bfi_b32 v16, s8, v40, v16
  v_bfi_b32 v17, s8, v41, v17
  v_bfi_b32 v18, s8, v42, v18
  v_bfi_b32 v19, s8, v43, v19
  v_cmp_gt_u32 vcc, 32, v0
  s_nop 1
  s_and_saveexec_b64 s[14:15], vcc
  buffer_store_dwordx4 v[16:19], v6, s[44:47], s96 offen sc1
  s_mov_b64 exec, s[14:15]
  s_waitcnt lgkmcnt(0)
  s_endpgm
L_w7b:
  s_nop 1
  s_waitcnt lgkmcnt(0)
  s_add_u32 s44, s42, 0
  s_addc_u32 s45, s43, 0
  s_mov_b32 s46, 7864320
  s_mov_b32 s47, 0x20000
  s_load_dword s60, s[44:45], 0
  v_and_b32 v4, 15, v0
  v_lshrrev_b32 v5, 4, v0
  v_lshlrev_b32 v6, 4, v0
  s_waitcnt lgkmcnt(0)
  s_add_u32 s60, s60, 1
  s_and_b32 s61, s60, 0xff
  s_xor_b32 s62, s61, 0xa5
  s_lshr_b32 s63, s60, 8
  s_and_b32 s63, s63, 0xff
  s_xor_b32 s63, s63, 0x96
  s_lshr_b32 s64, s60, 16
  s_and_b32 s64, s64, 0xff
  s_xor_b32 s64, s64, s61
  s_xor_b32 s64, s64, 0x3c
  s_lshr_b32 s12, s61, 0
  s_and_b32 s12, s12, 1
  s_lshr_b32 s13, s61, 1
  s_and_b32 s13, s13, 1
  s_lshl_b32 s13, s13, 16
  s_or_b32 s65, s12, s13
  s_lshr_b32 s12, s61, 2
  s_and_b32 s12, s12, 1
  s_lshr_b32 s13, s61, 3
  s_and_b32 s13, s13, 1
  s_lshl_b32 s13, s13, 16
  s_or_b32 s66, s12, s13
  s_lshr_b32 s12, s61, 4
  s_and_b32 s12, s12, 1
  s_lshr_b32 s13, s61, 5
  s_and_b32 s13, s13, 1
  s_lshl_b32 s13, s13, 16
  s_or_b32 s67, s12, s13
  s_lshr_b32 s12, s61, 6
  s_and_b32 s12, s12, 1
  s_lshr_b32 s13, s61, 7
  s_and_b32 s13, s13, 1
  s_lshl_b32 s13, s13, 16
  s_or_b32 s68, s12, s13
  s_barrier
  s_getreg_b32 s94, hwreg(HW_REG_XCC_ID)
  s_and_b32 s94, s94, 0xffff
  s_lshl_b32 s94, s94, 8
  v_mov_b32 v40, s61
  v_mov_b32 v41, s62
  v_mov_b32 v42, s63
  v_mov_b32 v43, s64
  v_mov_b32 v16, s94
  v_mov_b32 v17, 0
  v_mov_b32 v18, 0
  v_mov_b32 v19, 0
  v_bfi_b32 v16, s8, v40, v16
  v_bfi_b32 v17, s8, v41, v17
  v_bfi_b32 v18, s8, v42, v18
  v_bfi_b32 v19, s8, v43, v19
  s_lshl_b32 s98, s4, 9
  s_add_u32 s98, s98, 7143424
  s_lshl_b32 s12, s5, 4
  s_add_u32 s93, s98, s12
  v_mov_b32 v12, 0
  s_mov_b64 exec, 1
  buffer_store_dwordx4 v[16:19], v12, s[44:47], s93 offen sc1
  s_mov_b64 exec, -1
  s_barrier
  v_and_b32 v12, 31, v0
  v_lshlrev_b32 v12, 4, v12
  s_mov_b32 s69, 0
L_poll_68:
  buffer_load_dwordx4 v[20:23], v12, s[44:47], s98 offen sc1
  s_waitcnt vmcnt(0)
  v_xor_b32 v20, s61, v20
  v_xor_b32 v21, s62, v21
  v_xor_b32 v22, s63, v22
  v_xor_b32 v23, s64, v23
  v_or_b32 v1, v20, v21
  v_or3_b32 v1, v1, v22, v23
  v_and_b32 v1, s8, v1
  v_cmp_ne_u32 vcc, 0, v1
  s_cbranch_vccz L_done_69
  s_sleep 1
  s_add_u32 s69, s69, 1
  s_cmp_lt_u32 s69, 65536
  s_cbranch_scc1 L_poll_68
  s_mov_b32 s12, s40
  s_mov_b32 s13, s41
  s_mov_b32 s14, 256
  s_mov_b32 s15, 0x20000
  v_mov_b32 v2, 76
  v_mov_b32 v3, s2
  v_or_b32 v3, 0x10000, v3
  buffer_store_dword v3, v2, s[12:15], 0 offen
  s_waitcnt vmcnt(0)
L_done_69:
  s_nop 1
  v_cmp_ne_u32 vcc, s94, v20
  s_nop 1
  s_cmp_eq_u64 vcc, 0
  s_cselect_b32 s95, 1, 2
  v_mov_b32 v24, 133120
  v_mov_b32 v25, s95
  ds_write_b32 v24, v25 offset:16
  s_waitcnt lgkmcnt(0)
  s_endpgm
L_w7a:
  s_nop 1
  s_waitcnt lgkmcnt(0)
  s_add_u32 s44, s42, 0
  s_addc_u32 s45, s43, 0
  s_mov_b32 s46, 7864320
  s_mov_b32 s47, 0x20000
  s_load_dword s60, s[44:45], 0
  v_and_b32 v4, 15, v0
  v_lshrrev_b32 v5, 4, v0
  v_lshlrev_b32 v6, 4, v0
  s_endpgm
L_yab:
  s_nop 1
  s_barrier
  s_mov_b32 s48, s26
  s_mov_b32 s49, s27
  s_mov_b32 s50, 4194304
  s_mov_b32 s51, 0x20000
  v_lshlrev_b32 v7, 13, v5
  v_lshl_add_u32 v7, v4, 4, v7
  s_lshl_b32 s92, s6, 17
  s_lshl_b32 s12, s7, 8
  s_add_u32 s92, s92, s12
  s_lshl_b32 s94, s6, 13
  s_add_u32 s94, s94, 724992
  s_add_u32 s95, s94, 4096
  buffer_load_dword v3, v6, s[44:47], s94 offen offset:0
  buffer_load_dword v3, v6, s[44:47], s94 offen offset:1024
  buffer_load_dword v3, v6, s[44:47], s94 offen offset:2048
  buffer_load_dword v3, v6, s[44:47], s94 offen offset:3072
  buffer_load_dword v3, v6, s[44:47], s95 offen offset:0
  buffer_load_dword v3, v6, s[44:47], s95 offen offset:1024
  buffer_load_dword v3, v6, s[44:47], s95 offen offset:2048
  buffer_load_dword v3, v6, s[44:47], s95 offen offset:3072
  v_mov_b32 v60, 133120
  s_mov_b32 s69, 0
L_lspin_70:
  ds_read_b32 v61, v60 offset:8
  s_waitcnt lgkmcnt(0)
  v_cmp_ne_u32 vcc, 4, v61
  s_cbranch_vccz L_ldone_71
  s_add_u32 s69, s69, 1
  s_cmp_lt_u32 s69, 4194304
  s_cbranch_scc1 L_lspin_70
  s_mov_b32 s12, s40
  s_mov_b32 s13, s41
  s_mov_b32 s14, 256
  s_mov_b32 s15, 0x20000
  v_mov_b32 v2, 64
  v_mov_b32 v3, s2
  v_or_b32 v3, 0x10000, v3
  buffer_store_dword v3, v2, s[12:15], 0 offen
  s_waitcnt vmcnt(0)
L_ldone_71:
  s_nop 1
  buffer_load_dwordx4 v[64:67], v7, s[48:51], s92 offen nt
  s_add_u32 s92, s92, 1024
  buffer_load_dwordx4 v[68:71], v7, s[48:51], s92 offen nt
  s_add_u32 s92, s92, 1024
  buffer_load_dwordx4 v[72:75], v7, s[48:51], s92 offen nt
  s_add_u32 s92, s92, 1024
  buffer_load_dwordx4 v[76:79], v7, s[48:51], s92 offen nt
  s_add_u32 s92, s92, 1024
  buffer_load_dwordx4 v[80:83], v7, s[48:51], s92 offen nt
  s_add_u32 s92, s92, 1024
  buffer_load_dwordx4 v[84:87], v7, s[48:51], s92 offen nt
  s_add_u32 s92, s92, 1024
  buffer_load_dwordx4 v[88:91], v7, s[48:51], s92 offen nt
  s_add_u32 s92, s92, 1024
  buffer_load_dwordx4 v[92:95], v7, s[48:51], s92 offen nt
  s_add_u32 s92, s92, 25600
  buffer_load_dwordx4 v[96:99], v7, s[48:51], s92 offen nt
  s_add_u32 s92, s92, 1024
  buffer_load_dwordx4 v[100:103], v7, s[48:51], s92 offen nt
  s_add_u32 s92, s92, 1024
  buffer_load_dwordx4 v[104:107], v7, s[48:51], s92 offen nt
  s_add_u32 s92, s92, 1024
  buffer_load_dwordx4 v[108:111], v7, s[48:51], s92 offen nt
  s_add_u32 s92, s92, 1024
  buffer_load_dwordx4 v[112:115], v7, s[48:51], s92 offen nt
  s_add_u32 s92, s92, 1024
  buffer_load_dwordx4 v[116:119], v7, s[48:51], s92 offen nt
  s_add_u32 s92, s92, 1024
  buffer_load_dwordx4 v[120:123], v7, s[48:51], s92 offen nt
  s_add_u32 s92, s92, 1024
  buffer_load_dwordx4 v[124:127], v7, s[48:51], s92 offen nt
  s_add_u32 s92, s92, 25600
  buffer_load_dwordx4 v[128:131], v7, s[48:51], s92 offen nt
  s_add_u32 s92, s92, 1024
  buffer_load_dwordx4 v[132:135], v7, s[48:51], s92 offen nt
  s_add_u32 s92, s92, 1024
  buffer_load_dwordx4 v[136:139], v7, s[48:51], s92 offen nt
  s_add_u32 s92, s92, 1024
  buffer_load_dwordx4 v[140:143], v7, s[48:51], s92 offen nt
  s_add_u32 s92, s92, 1024
  buffer_load_dwordx4 v[144:147], v7, s[48:51], s92 offen nt
  s_add_u32 s92, s92, 1024
  buffer_load_dwordx4 v[148:151], v7, s[48:51], s92 offen nt
  s_add_u32 s92, s92, 1024
  buffer_load_dwordx4 v[152:155], v7, s[48:51], s92 offen nt
  s_add_u32 s92, s92, 1024
  buffer_load_dwordx4 v[156:159], v7, s[48:51], s92 offen nt
  s_add_u32 s92, s92, 25600
  buffer_load_dwordx4 v[160:163], v7, s[48:51], s92 offen nt
  s_add_u32 s92, s92, 1024
  buffer_load_dwordx4 v[164:167], v7, s[48:51], s92 offen nt
  s_add_u32 s92, s92, 1024
  buffer_load_dwordx4 v[168:171], v7, s[48:51], s92 offen nt
  s_add_u32 s92, s92, 1024
  buffer_load_dwordx4 v[172:175], v7, s[48:51], s92 offen nt
  s_add_u32 s92, s92, 1024
  buffer_load_dwordx4 v[176:179], v7, s[48:51], s92 offen nt
  s_add_u32 s92, s92, 1024
  buffer_load_dwordx4 v[180:183], v7, s[48:51], s92 offen nt
  s_add_u32 s92, s92, 1024
  buffer_load_dwordx4 v[184:187], v7, s[48:51], s92 offen nt
  s_add_u32 s92, s92, 1024
  buffer_load_dwordx4 v[188:191], v7, s[48:51], s92 offen nt
  v_add_u32 v9, 148480, v6
  v_lshrrev_b32 v10, 2, v4
  v_lshlrev_b32 v10, 8, v10
  v_lshl_add_u32 v10, v5, 4, v10
  v_add_u32 v10, 148480, v10
  s_waitcnt vmcnt(24)
  v_perm_b32 v192, v68, v64, s10
  v_perm_b32 v196, v68, v64, s11
  v_perm_b32 v193, v76, v72, s10
  v_perm_b32 v197, v76, v72, s11
  v_perm_b32 v194, v84, v80, s10
  v_perm_b32 v198, v84, v80, s11
  v_perm_b32 v195, v92, v88, s10
  v_perm_b32 v199, v92, v88, s11
  v_perm_b32 v200, v69, v65, s10
  v_perm_b32 v204, v69, v65, s11
  v_perm_b32 v201, v77, v73, s10
  v_perm_b32 v205, v77, v73, s11
  v_perm_b32 v202, v85, v81, s10
  v_perm_b32 v206, v85, v81, s11
  v_perm_b32 v203, v93, v89, s10
  v_perm_b32 v207, v93, v89, s11
  v_perm_b32 v208, v70, v66, s10
  v_perm_b32 v212, v70, v66, s11
  v_perm_b32 v209, v78, v74, s10
  v_perm_b32 v213, v78, v74, s11
  v_perm_b32 v210, v86, v82, s10
  v_perm_b32 v214, v86, v82, s11
  v_perm_b32 v211, v94, v90, s10
  v_perm_b32 v215, v94, v90, s11
  v_perm_b32 v216, v71, v67, s10
  v_perm_b32 v220, v71, v67, s11
  v_perm_b32 v217, v79, v75, s10
  v_perm_b32 v221, v79, v75, s11
  v_perm_b32 v218, v87, v83, s10
  v_perm_b32 v222, v87, v83, s11
  v_perm_b32 v219, v95, v91, s10
  v_perm_b32 v223, v95, v91, s11
  s_waitcnt vmcnt(16)
  v_perm_b32 v64, v100, v96, s10
  v_perm_b32 v68, v100, v96, s11
  v_perm_b32 v65, v108, v104, s10
  v_perm_b32 v69, v108, v104, s11
  v_perm_b32 v66, v116, v112, s10
  v_perm_b32 v70, v116, v112, s11
  v_perm_b32 v67, v124, v120, s10
  v_perm_b32 v71, v124, v120, s11
  v_perm_b32 v72, v101, v97, s10
  v_perm_b32 v76, v101, v97, s11
  v_perm_b32 v73, v109, v105, s10
  v_perm_b32 v77, v109, v105, s11
  v_perm_b32 v74, v117, v113, s10
  v_perm_b32 v78, v117, v113, s11
  v_perm_b32 v75, v125, v121, s10
  v_perm_b32 v79, v125, v121, s11
  v_perm_b32 v80, v102, v98, s10
  v_perm_b32 v84, v102, v98, s11
  v_perm_b32 v81, v110, v106, s10
  v_perm_b32 v85, v110, v106, s11
  v_perm_b32 v82, v118, v114, s10
  v_perm_b32 v86, v118, v114, s11
  v_perm_b32 v83, v126, v122, s10
  v_perm_b32 v87, v126, v122, s11
  v_perm_b32 v88, v103, v99, s10
  v_perm_b32 v92, v103, v99, s11
  v_perm_b32 v89, v111, v107, s10
  v_perm_b32 v93, v111, v107, s11
  v_perm_b32 v90, v119, v115, s10
  v_perm_b32 v94, v119, v115, s11
  v_perm_b32 v91, v127, v123, s10
  v_perm_b32 v95, v127, v123, s11
  s_waitcnt vmcnt(8)
  v_perm_b32 v96, v132, v128, s10
  v_perm_b32 v100, v132, v128, s11
  v_perm_b32 v97, v140, v136, s10
  v_perm_b32 v101, v140, v136, s11
  v_perm_b32 v98, v148, v144, s10
  v_perm_b32 v102, v148, v144, s11
  v_perm_b32 v99, v156, v152, s10
  v_perm_b32 v103, v156, v152, s11
  v_perm_b32 v104, v133, v129, s10
  v_perm_b32 v108, v133, v129, s11
  v_perm_b32 v105, v141, v137, s10
  v_perm_b32 v109, v141, v137, s11
  v_perm_b32 v106, v149, v145, s10
  v_perm_b32 v110, v149, v145, s11
  v_perm_b32 v107, v157, v153, s10
  v_perm_b32 v111, v157, v153, s11
  v_perm_b32 v112, v134, v130, s10
  v_perm_b32 v116, v134, v130, s11
  v_perm_b32 v113, v142, v138, s10
  v_perm_b32 v117, v142, v138, s11
  v_perm_b32 v114, v150, v146, s10
  v_perm_b32 v118, v150, v146, s11
  v_perm_b32 v115, v158, v154, s10
  v_perm_b32 v119, v158, v154, s11
  v_perm_b32 v120, v135, v131, s10
  v_perm_b32 v124, v135, v131, s11
  v_perm_b32 v121, v143, v139, s10
  v_perm_b32 v125, v143, v139, s11
  v_perm_b32 v122, v151, v147, s10
  v_perm_b32 v126, v151, v147, s11
  v_perm_b32 v123, v159, v155, s10
  v_perm_b32 v127, v159, v155, s11
  s_waitcnt vmcnt(0)
  v_perm_b32 v128, v164, v160, s10
  v_perm_b32 v132, v164, v160, s11
  v_perm_b32 v129, v172, v168, s10
  v_perm_b32 v133, v172, v168, s11
  v_perm_b32 v130, v180, v176, s10
  v_perm_b32 v134, v180, v176, s11
  v_perm_b32 v131, v188, v184, s10
  v_perm_b32 v135, v188, v184, s11
  v_perm_b32 v136, v165, v161, s10
  v_perm_b32 v140, v165, v161, s11
  v_perm_b32 v137, v173, v169, s10
  v_perm_b32 v141, v173, v169, s11
  v_perm_b32 v138, v181, v177, s10
  v_perm_b32 v142, v181, v177, s11
  v_perm_b32 v139, v189, v185, s10
  v_perm_b32 v143, v189, v185, s11
  v_perm_b32 v144, v166, v162, s10
  v_perm_b32 v148, v166, v162, s11
  v_perm_b32 v145, v174, v170, s10
  v_perm_b32 v149, v174, v170, s11
  v_perm_b32 v146, v182, v178, s10
  v_perm_b32 v150, v182, v178, s11
  v_perm_b32 v147, v190, v186, s10
  v_perm_b32 v151, v190, v186, s11
  v_perm_b32 v152, v167, v163, s10
  v_perm_b32 v156, v167, v163, s11
  v_perm_b32 v153, v175, v171, s10
  v_perm_b32 v157, v175, v171, s11
  v_perm_b32 v154, v183, v179, s10
  v_perm_b32 v158, v183, v179, s11
  v_perm_b32 v155, v191, v187, s10
  v_perm_b32 v159, v191, v187, s11
  s_lshl_b32 s92, s6, 13
  s_add_u32 s92, s92, 724992
  s_add_u32 s93, s92, 4096
  s_lshl_b32 s96, s6, 2
  s_add_u32 s96, s96, s7
  s_lshl_b32 s96, s96, 11
  s_add_u32 s96, s96, 1511424
  s_mov_b32 s69, 0
L_spl_72:
  buffer_load_dwordx4 v[32:35], v6, s[44:47], s92 offen offset:0 sc1
  buffer_load_dwordx4 v[36:39], v6, s[44:47], s92 offen offset:1024 sc1
  buffer_load_dwordx4 v[40:43], v6, s[44:47], s92 offen offset:2048 sc1
  buffer_load_dwordx4 v[44:47], v6, s[44:47], s92 offen offset:3072 sc1
  buffer_load_dwordx4 v[48:51], v6, s[44:47], s93 offen offset:0 sc1
  buffer_load_dwordx4 v[52:55], v6, s[44:47], s93 offen offset:1024 sc1
  buffer_load_dwordx4 v[56:59], v6, s[44:47], s93 offen offset:2048 sc1
  buffer_load_dwordx4 v[60:63], v6, s[44:47], s93 offen offset:3072 sc1
  s_waitcnt vmcnt(7)
  v_xor_b32 v32, s61, v32
  v_xor_b32 v33, s62, v33
  v_xor_b32 v34, s63, v34
  v_xor_b32 v35, s64, v35
  v_or_b32 v1, v32, v33
  v_or3_b32 v1, v1, v34, v35
  v_mov_b32 v16, v32
  v_mov_b32 v17, v33
  v_mov_b32 v18, v34
  v_mov_b32 v19, v35
  s_waitcnt vmcnt(6)
  v_xor_b32 v36, s61, v36
  v_xor_b32 v37, s62, v37
  v_xor_b32 v38, s63, v38
  v_xor_b32 v39, s64, v39
  v_or3_b32 v1, v1, v36, v37
  v_or3_b32 v1, v1, v38, v39
  v_mov_b32 v20, v36
  v_mov_b32 v21, v37
  v_mov_b32 v22, v38
  v_mov_b32 v23, v39
  s_waitcnt vmcnt(5)
  v_xor_b32 v40, s61, v40
  v_xor_b32 v41, s62, v41
  v_xor_b32 v42, s63, v42
  v_xor_b32 v43, s64, v43
  v_or3_b32 v1, v1, v40, v41
  v_or3_b32 v1, v1, v42, v43
  v_add_f32 v16, v16, v40
  v_add_f32 v17, v17, v41
  v_add_f32 v18, v18, v42
  v_add_f32 v19, v19, v43
  s_waitcnt vmcnt(4)
  v_xor_b32 v44, s61, v44
  v_xor_b32 v45, s62, v45
  v_xor_b32 v46, s63, v46
  v_xor_b32 v47, s64, v47
  v_or3_b32 v1, v1, v44, v45
  v_or3_b32 v1, v1, v46, v47
  v_add_f32 v20, v20, v44
  v_add_f32 v21, v21, v45
  v_add_f32 v22, v22, v46
  v_add_f32 v23, v23, v47
  s_waitcnt vmcnt(3)
  v_xor_b32 v48, s61, v48
  v_xor_b32 v49, s62, v49
  v_xor_b32 v50, s63, v50
  v_xor_b32 v51, s64, v51
  v_or3_b32 v1, v1, v48, v49
  v_or3_b32 v1, v1, v50, v51
  v_add_f32 v16, v16, v48
  v_add_f32 v17, v17, v49
  v_add_f32 v18, v18, v50
  v_add_f32 v19, v19, v51
  s_waitcnt vmcnt(2)
  v_xor_b32 v52, s61, v52
  v_xor_b32 v53, s62, v53
  v_xor_b32 v54, s63, v54
  v_xor_b32 v55, s64, v55
  v_or3_b32 v1, v1, v52, v53
  v_or3_b32 v1, v1, v54, v55
  v_add_f32 v20, v20, v52
  v_add_f32 v21, v21, v53
  v_add_f32 v22, v22, v54
  v_add_f32 v23, v23, v55
  s_waitcnt vmcnt(1)
  v_xor_b32 v56, s61, v56
  v_xor_b32 v57, s62, v57
  v_xor_b32 v58, s63, v58
  v_xor_b32 v59, s64, v59
  v_or3_b32 v1, v1, v56, v57
  v_or3_b32 v1, v1, v58, v59
  v_add_f32 v16, v16, v56
  v_add_f32 v17, v17, v57
  v_add_f32 v18, v18, v58
  v_add_f32 v19, v19, v59
  s_waitcnt vmcnt(0)
  v_xor_b32 v60, s61, v60
  v_xor_b32 v61, s62, v61
  v_xor_b32 v62, s63, v62
  v_xor_b32 v63, s64, v63
  v_or3_b32 v1, v1, v60, v61
  v_or3_b32 v1, v1, v62, v63
  v_add_f32 v20, v20, v60
  v_add_f32 v21, v21, v61
  v_add_f32 v22, v22, v62
  v_add_f32 v23, v23, v63
  v_and_b32 v1, s8, v1
  v_cmp_ne_u32 vcc, 0, v1
  s_cbranch_vccz L_spd_73
  s_sleep 1
  s_add_u32 s69, s69, 1
  s_cmp_lt_u32 s69, 65536
  s_cbranch_scc1 L_spl_72
  s_mov_b32 s12, s40
  s_mov_b32 s13, s41
  s_mov_b32 s14, 256
  s_mov_b32 s15, 0x20000
  v_mov_b32 v2, 28
  v_mov_b32 v3, s2
  v_or_b32 v3, 0x10000, v3
  buffer_store_dword v3, v2, s[12:15], 0 offen
  s_waitcnt vmcnt(0)
L_spd_73:
  s_nop 1
  v_cvt_pk_bf16_f32 v12, v16, v17
  v_cvt_pk_bf16_f32 v13, v18, v19
  v_cvt_pk_bf16_f32 v14, v20, v21
  v_cvt_pk_bf16_f32 v15, v22, v23
  ds_write_b128 v9, v[12:15]
  ds_read_b128 v[16:19], v10 offset:0
  ds_read_b128 v[20:23], v10 offset:64
  ds_read_b128 v[24:27], v10 offset:128
  ds_read_b128 v[28:31], v10 offset:192
  s_waitcnt lgkmcnt(0)
  v_mfma_f32_16x16x32_bf16 v[224:227], v[16:19], v[192:195], 0
  v_mfma_f32_16x16x32_bf16 v[228:231], v[16:19], v[196:199], 0
  v_mfma_f32_16x16x32_bf16 v[232:235], v[16:19], v[200:203], 0
  v_mfma_f32_16x16x32_bf16 v[236:239], v[16:19], v[204:207], 0
  v_mfma_f32_16x16x32_bf16 v[240:243], v[16:19], v[208:211], 0
  v_mfma_f32_16x16x32_bf16 v[244:247], v[16:19], v[212:215], 0
  v_mfma_f32_16x16x32_bf16 v[248:251], v[16:19], v[216:219], 0
  v_mfma_f32_16x16x32_bf16 v[252:255], v[16:19], v[220:223], 0
  v_mfma_f32_16x16x32_bf16 v[224:227], v[20:23], v[64:67], v[224:227]
  v_mfma_f32_16x16x32_bf16 v[228:231], v[20:23], v[68:71], v[228:231]
  v_mfma_f32_16x16x32_bf16 v[232:235], v[20:23], v[72:75], v[232:235]
  v_mfma_f32_16x16x32_bf16 v[236:239], v[20:23], v[76:79], v[236:239]
  v_mfma_f32_16x16x32_bf16 v[240:243], v[20:23], v[80:83], v[240:243]
  v_mfma_f32_16x16x32_bf16 v[244:247], v[20:23], v[84:87], v[244:247]
  v_mfma_f32_16x16x32_bf16 v[248:251], v[20:23], v[88:91], v[248:251]
  v_mfma_f32_16x16x32_bf16 v[252:255], v[20:23], v[92:95], v[252:255]
  v_mfma_f32_16x16x32_bf16 v[224:227], v[24:27], v[96:99], v[224:227]
  v_mfma_f32_16x16x32_bf16 v[228:231], v[24:27], v[100:103], v[228:231]
  v_mfma_f32_16x16x32_bf16 v[232:235], v[24:27], v[104:107], v[232:235]
  v_mfma_f32_16x16x32_bf16 v[236:239], v[24:27], v[108:111], v[236:239]
  v_mfma_f32_16x16x32_bf16 v[240:243], v[24:27], v[112:115], v[240:243]
  v_mfma_f32_16x16x32_bf16 v[244:247], v[24:27], v[116:119], v[244:247]
  v_mfma_f32_16x16x32_bf16 v[248:251], v[24:27], v[120:123], v[248:251]
  v_mfma_f32_16x16x32_bf16 v[252:255], v[24:27], v[124:127], v[252:255]
  v_mfma_f32_16x16x32_bf16 v[224:227], v[28:31], v[128:131], v[224:227]
  v_mfma_f32_16x16x32_bf16 v[228:231], v[28:31], v[132:135], v[228:231]
  v_mfma_f32_16x16x32_bf16 v[232:235], v[28:31], v[136:139], v[232:235]
  v_mfma_f32_16x16x32_bf16 v[236:239], v[28:31], v[140:143], v[236:239]
  v_mfma_f32_16x16x32_bf16 v[240:243], v[28:31], v[144:147], v[240:243]
  v_mfma_f32_16x16x32_bf16 v[244:247], v[28:31], v[148:151], v[244:247]
  v_mfma_f32_16x16x32_bf16 v[248:251], v[28:31], v[152:155], v[248:251]
  v_mfma_f32_16x16x32_bf16 v[252:255], v[28:31], v[156:159], v[252:255]
  v_mov_b32 v24, s61
  v_mov_b32 v25, s62
  v_mov_b32 v26, s63
  v_mov_b32 v27, s64
  v_bfi_b32 v16, s8, v24, v224
  v_bfi_b32 v17, s8, v25, v228
  v_bfi_b32 v18, s8, v26, v232
  v_bfi_b32 v19, s8, v27, v236
  v_bfi_b32 v20, s8, v24, v240
  v_bfi_b32 v21, s8, v25, v244
  v_bfi_b32 v22, s8, v26, v248
  v_bfi_b32 v23, s8, v27, v252
  buffer_store_dwordx4 v[16:19], v6, s[44:47], s96 offen offset:0 sc1
  buffer_store_dwordx4 v[20:23], v6, s[44:47], s96 offen offset:1024 sc1
  s_endpgm
L_end:
  s_endpgm
L_code_end:
.section .rodata,"a"
.p2align 6
.amdhsa_kernel concat_heads__compressed_kv_cla__sliding_block_cached__decode_kernel
  .amdhsa_next_free_vgpr 256
  .amdhsa_next_free_sgpr 102
  .amdhsa_accum_offset 256
  .amdhsa_group_segment_fixed_size 0
  .amdhsa_kernarg_size 112
  .amdhsa_user_sgpr_count 2
  .amdhsa_user_sgpr_kernarg_segment_ptr 1
  .amdhsa_system_sgpr_workgroup_id_x 1
.end_amdhsa_kernel
```
